```python
import torch

def _softmax(x, axis=-1):
    return torch.softmax(x, dim=axis)
def _gelu(x):
    return torch.nn.functional.gelu(x, approximate="tanh")
def _silu(x):
    return torch.nn.functional.silu(x)
def _sigmoid(x):
    return torch.sigmoid(x)
def _layernorm(x, axis=-1, eps=1e-5):
    m = x.mean(dim=axis, keepdim=True)
    v = x.var(dim=axis, keepdim=True, unbiased=False)
    return (x - m) / torch.sqrt(v + eps)
def _scatter_add(tgt, idx, src, axis=0):
    return tgt.clone().index_add_(axis, idx, src)
def _segment_sum(src, seg, n):
    out = torch.zeros((n,) + src.shape[1:], dtype=src.dtype)
    return out.index_add_(0, seg, src)
def _pad(x, pw):
    flat = tuple(v for pair in reversed(pw) for v in pair)
    return torch.nn.functional.pad(x, flat)

kernel_name = 'sequential_preLN__compressed_kv_cla__glu_gated_reglu__decode'

def setup_inputs():

    _w = (lambda a: (lambda t: t.to(torch.bfloat16) if t.is_floating_point() else t)(torch.as_tensor(a)))
    def _A_setup():
        B, H, Sq, Sk, D, M = 4, 32, 1, 4096, 128, 512
        Dc = 4 * D
        return {
            "x": _w((lambda *s: torch.randn(*s, dtype=torch.bfloat16) * 0.05)(B, Sq, M)),
            "c_kv": _w((lambda *s: torch.randn(*s, dtype=torch.bfloat16) * 0.8)(B, Sk, Dc)),
            "w_q": _w((lambda *s: torch.randn(*s, dtype=torch.bfloat16) * 1.6)(M, H, D) * (M ** -0.5)),
            "w_uk": _w((lambda *s: torch.randn(*s, dtype=torch.bfloat16) * 1.6)(Dc, H, D) * (Dc ** -0.5)),
            "w_uv": _w((lambda *s: torch.randn(*s, dtype=torch.bfloat16) * 0.8)(Dc, H, D) * (Dc ** -0.5)),
            "w_o": _w((lambda *s: torch.randn(*s, dtype=torch.bfloat16) * 0.8)(H, D, M) * ((H * D) ** -0.5)),
        }
    _A_in = _A_setup()

    def _B_setup():
        B, S, D, F = 4, 1, 512, 1792
        return {
            "x": _w((lambda *s: torch.randn(*s, dtype=torch.bfloat16) * 0.05)(B, S, D)),
            "W_gate": _w((lambda *s: torch.randn(*s, dtype=torch.bfloat16) * 0.4)(D, F) * (2.0 / D) ** 0.5),
            "W_up": _w((lambda *s: torch.randn(*s, dtype=torch.bfloat16) * 0.4)(D, F) * (2.0 / D) ** 0.5),
            "W_down": _w((lambda *s: torch.randn(*s, dtype=torch.bfloat16) * 0.4)(F, D) * (1.0 / F) ** 0.5),
        }
    _B_in = _B_setup()

    return {
        "A_x": _A_in["x"],
        "A_c_kv": _A_in["c_kv"],
        "A_w_q": _A_in["w_q"],
        "A_w_uk": _A_in["w_uk"],
        "A_w_uv": _A_in["w_uv"],
        "A_w_o": _A_in["w_o"],
        "B_x": _B_in["x"],
        "B_W_gate": _B_in["W_gate"],
        "B_W_up": _B_in["W_up"],
        "B_W_down": _B_in["W_down"],
    }

def reference(A_x, A_c_kv, A_w_q, A_w_uk, A_w_uv, A_w_o, B_x, B_W_gate, B_W_up, B_W_down):
    def _A_ref(x, c_kv, w_q, w_uk, w_uv, w_o):
        B, Sq, M = x.shape[0], x.shape[1], x.shape[2]
        Sk = c_kv.shape[1]
        H, D = w_q.shape[1], w_q.shape[2]
        q = torch.einsum("bqm,mhd->bhqd", x, w_q)
        k = torch.einsum("bkc,chd->bhkd", c_kv, w_uk)
        v = torch.einsum("bkc,chd->bhkd", c_kv, w_uv)
        scores = torch.einsum("bhqd,bhkd->bhqk", q, k) * (D ** -0.5)
        off = Sk - Sq
        qi = torch.arange(Sq)[:, None]
        kj = torch.arange(Sk)[None, :]
        cmask = kj <= (qi + off)
        scores = torch.where(cmask[None, None], scores, -1e9)
        p = _softmax(scores, axis=-1)
        ctx = torch.einsum("bhqk,bhkd->bhqd", p, v)
        return torch.einsum("bhqd,hdm->bqm", ctx, w_o)

    def _B_ref(x, W_gate, W_up, W_down):
        gate = torch.einsum("bsd,df->bsf", x, W_gate)
        up = torch.einsum("bsd,df->bsf", x, W_up)
        gate = gate * (lambda x, dt: x.to(dt))(gate > 0, gate.dtype)
        h = gate * up
        return torch.einsum("bsf,fd->bsd", h, W_down)

    x = A_x
    h = x + _A_ref(_layernorm(x, axis=-1), A_c_kv, A_w_q, A_w_uk, A_w_uv, A_w_o)
    h2 = h + _B_ref(_layernorm(h, axis=-1), B_W_gate, B_W_up, B_W_down)
    return h2
```

```asm
; @launch grid=(256,1,1) block=(512,1,1) lds=163840
.amdgcn_target "amdgcn-amd-amdhsa--gfx950"
.text
.globl sequential_preLN__compressed_kv_cla__glu_gated_reglu__decode_kernel
.p2align 8
.type sequential_preLN__compressed_kv_cla__glu_gated_reglu__decode_kernel,@function
sequential_preLN__compressed_kv_cla__glu_gated_reglu__decode_kernel:
s_getpc_b64 s[70:71]
s_cmp_ge_u32 s2, 256
s_cbranch_scc1 L_done
s_load_dwordx16 s[8:23], s[0:1], 0
s_load_dwordx8 s[24:31], s[0:1], 64
s_load_dwordx2 s[32:33], s[0:1], 96
v_lshrrev_b32 v1, 6, v0
v_and_b32 v8, 255, v0
v_readfirstlane_b32 s5, v1
v_and_b32 v0, 63, v0
s_and_b32 s3, s2, 7
s_lshr_b32 s4, s2, 3
s_mov_b32 s34, 0
s_mov_b32 s35, 0

s_cmp_lg_u32 s5, 7
s_cbranch_scc1 L_nopf
s_cmp_lt_u32 s4, 0
s_cbranch_scc1 L_nopf
s_and_b32 s6, s4, 3
s_mul_i32 s6, s6, 5760
v_lshlrev_b32 v8, 7, v0
v_min_u32 v8, 5632, v8
v_add_u32 v8, s6, v8
global_load_dword v255, v8, s[70:71] offset:-4
L_nopf:
v_mov_b32 v254, 0
v_mov_b32 v1, 152576
s_lshl_b32 s6, s5, 2
v_add_u32 v6, s6, v1
s_lshl_b32 s52, s3, 2
s_lshr_b32 s6, s4, 3
s_add_u32 s52, s52, s6
s_and_b32 s53, s4, 7
v_and_b32 v2, 3, v0
v_bfe_u32 v3, v0, 2, 2
v_lshrrev_b32 v4, 4, v0
v_and_b32 v5, 15, v0
v_lshlrev_b32 v7, 4, v0
s_mov_b32 s38, 268435456
s_mov_b32 s39, 0x20000
s_mov_b32 s60, 0x000f000f
s_mov_b32 s61, 0x000f000f
s_mov_b32 s62, 0x00f000f0
s_mov_b32 s63, 0x00f000f0
v_and_b32 v9, 7, v0
v_lshlrev_b32 v10, 1, v4
v_xor_b32 v9, v9, v10
v_lshlrev_b32 v9, 4, v9
v_bfe_u32 v19, v0, 3, 2
v_lshrrev_b32 v18, 5, v0
v_lshl_add_u32 v19, v18, 3, v19
s_cmp_lt_u32 s5, 4
s_cbranch_scc1 L_p1
s_and_b32 s57, s5, 3
s_waitcnt lgkmcnt(0)
s_mov_b32 s36, s32
s_and_b32 s37, s33, 0xffff
s_load_dword s69, s[32:33], 0
s_cmp_ge_u32 s4, 16
s_cbranch_scc1 L_rhi
s_barrier
s_branch L_att
L_p1:
s_cmp_lg_u32 s5, 0
s_cbranch_scc1 L_noinit
v_lshl_add_u32 v8, v0, 3, v1
v_mov_b32 v12, 0
v_mov_b32 v13, 0
ds_write_b64 v8, v[12:13]
L_noinit:
v_lshl_add_u32 v10, v19, 13, v9
v_add_u32 v11, 131072, v10
v_add_u32 v12, 32768, v10
v_add_u32 v13, 163840, v10
s_lshr_b32 s54, s53, 1
s_lshl_b32 s54, s54, 20
s_lshl_b32 s55, s52, 8
s_add_u32 s54, s54, s55
s_and_b32 s56, s53, 1
s_lshl_b32 s56, s56, 7
s_add_u32 s54, s54, s56
s_lshl_b32 s56, s5, 18
s_add_u32 s54, s54, s56
s_mul_i32 s56, s5, 1040
s_add_u32 m0, s56, 147456
s_lshl_b32 s56, s5, 10
s_lshl_b32 s58, s5, 12
s_add_u32 s58, s58, 131072
s_mov_b32 s42, 4194304
s_mov_b32 s43, 0x20000
s_mov_b32 s46, 4096
s_mov_b32 s47, 0x20000
s_waitcnt lgkmcnt(0)
s_mov_b32 s44, s8
s_and_b32 s45, s9, 0xffff
s_mov_b32 s40, s12
s_and_b32 s41, s13, 0xffff
buffer_load_dwordx4 v7, s[44:47], s56 offen lds
s_mov_b32 m0, s58
s_load_dword s69, s[32:33], 0
buffer_load_dwordx4 v10, s[40:43], s54 offen nt lds
s_add_u32 m0, m0, 1024
s_mov_b32 s36, s32
buffer_load_dwordx4 v11, s[40:43], s54 offen nt lds
s_add_u32 m0, m0, 1024
s_and_b32 s37, s33, 0xffff
buffer_load_dwordx4 v12, s[40:43], s54 offen nt lds
s_add_u32 m0, m0, 1024
s_nop 0
buffer_load_dwordx4 v13, s[40:43], s54 offen nt lds
s_barrier
s_mov_b32 s64, 0x0f000f00
s_mov_b32 s65, 0x0f000f00
s_mov_b32 s66, 0xf000f000
s_mov_b32 s67, 0xf000f000
v_mul_u32_u24 v32, 1040, v2
v_add_u32 v32, 147456, v32
v_lshrrev_b32 v35, 2, v0
v_lshl_add_u32 v33, v35, 6, v32
v_lshl_add_u32 v34, v3, 6, v32
v_lshl_add_u32 v34, v4, 4, v34
s_lshr_b32 s54, s53, 1
s_lshl_b32 s55, s54, 8
v_add_u32 v34, s55, v34
v_bfe_u32 v36, v0, 3, 2
v_xor_b32 v36, s5, v36
v_lshlrev_b32 v36, 5, v36
v_lshl_add_u32 v36, v35, 7, v36
v_lshl_add_u32 v36, v2, 3, v36
v_add_u32 v36, 131072, v36
v_lshlrev_b32 v37, 4, v2
v_lshl_add_u32 v37, v4, 6, v37
s_mul_i32 s55, s52, 135168
s_lshl_b32 s56, s54, 11
s_add_u32 s55, s55, s56
s_and_b32 s56, s53, 1
s_lshl_b32 s56, s56, 10
s_add_u32 s55, s55, s56
s_lshl_b32 s56, s5, 8
s_add_u32 s55, s55, s56
s_add_u32 s55, s55, 2097152
s_mov_b32 s57, 0x3f803f80
v_mov_b32 v30, 0
v_mov_b32 v31, 0
s_waitcnt vmcnt(4)
ds_write_b32 v6, v6 offset:0
W_1:
ds_read_b128 v[56:59], v1 offset:0
ds_read_b128 v[8:11], v33 offset:0
ds_read_b128 v[12:15], v33 offset:16
ds_read_b128 v[16:19], v33 offset:32
ds_read_b128 v[20:23], v33 offset:48
ds_read_b128 v[24:27], v34
s_waitcnt lgkmcnt(0)
v_min_u32 v56, v56, v57
v_min3_u32 v56, v56, v58, v59
v_cmp_le_u32 vcc, 1, v56
s_cbranch_vccnz D_2
s_add_u32 s34, s34, 1
s_cmp_lt_u32 s34, 2097152
s_cbranch_scc0 L_done
s_branch W_1
D_2:
v_dot2_f32_bf16 v30, v8, s57, v30
v_dot2_f32_bf16 v31, v8, v8, v31
v_dot2_f32_bf16 v30, v9, s57, v30
v_dot2_f32_bf16 v31, v9, v9, v31
v_dot2_f32_bf16 v30, v10, s57, v30
v_dot2_f32_bf16 v31, v10, v10, v31
v_dot2_f32_bf16 v30, v11, s57, v30
v_dot2_f32_bf16 v31, v11, v11, v31
v_dot2_f32_bf16 v30, v12, s57, v30
v_dot2_f32_bf16 v31, v12, v12, v31
v_dot2_f32_bf16 v30, v13, s57, v30
v_dot2_f32_bf16 v31, v13, v13, v31
v_dot2_f32_bf16 v30, v14, s57, v30
v_dot2_f32_bf16 v31, v14, v14, v31
v_dot2_f32_bf16 v30, v15, s57, v30
v_dot2_f32_bf16 v31, v15, v15, v31
v_dot2_f32_bf16 v30, v16, s57, v30
v_dot2_f32_bf16 v31, v16, v16, v31
v_dot2_f32_bf16 v30, v17, s57, v30
v_dot2_f32_bf16 v31, v17, v17, v31
v_dot2_f32_bf16 v30, v18, s57, v30
v_dot2_f32_bf16 v31, v18, v18, v31
v_dot2_f32_bf16 v30, v19, s57, v30
v_dot2_f32_bf16 v31, v19, v19, v31
v_dot2_f32_bf16 v30, v20, s57, v30
v_dot2_f32_bf16 v31, v20, v20, v31
v_dot2_f32_bf16 v30, v21, s57, v30
v_dot2_f32_bf16 v31, v21, v21, v31
v_dot2_f32_bf16 v30, v22, s57, v30
v_dot2_f32_bf16 v31, v22, v22, v31
v_dot2_f32_bf16 v30, v23, s57, v30
v_dot2_f32_bf16 v31, v23, v23, v31
v_lshlrev_b32 v40, 16, v24
v_and_b32 v41, 0xffff0000, v24
v_lshlrev_b32 v42, 16, v25
v_and_b32 v43, 0xffff0000, v25
v_lshlrev_b32 v44, 16, v26
v_and_b32 v45, 0xffff0000, v26
v_lshlrev_b32 v46, 16, v27
v_and_b32 v47, 0xffff0000, v27
v_add_f32_dpp v30, v30, v30 row_ror:4 row_mask:0xf bank_mask:0xf
v_add_f32_dpp v31, v31, v31 row_ror:4 row_mask:0xf bank_mask:0xf
s_nop 0
v_add_f32_dpp v30, v30, v30 row_ror:8 row_mask:0xf bank_mask:0xf
v_add_f32_dpp v31, v31, v31 row_ror:8 row_mask:0xf bank_mask:0xf
v_mov_b32 v32, v30
v_mov_b32 v33, v31
s_nop 0
v_permlane16_swap_b32 v30, v32
v_permlane16_swap_b32 v31, v33
v_add_f32 v30, v30, v32
v_add_f32 v31, v31, v33
v_mov_b32 v32, v30
v_mov_b32 v33, v31
s_nop 0
v_permlane32_swap_b32 v30, v32
v_permlane32_swap_b32 v31, v33
v_add_f32 v30, v30, v32
v_add_f32 v31, v31, v33
s_add_u32 s69, s69, 1
s_mul_i32 s68, s69, 0x9e3779b1
v_mov_b32 v61, s68
v_mov_b32 v63, s68
v_mul_f32 v30, 0x3b000000, v30
v_mul_f32 v31, 0x3b000000, v31
v_fma_f32 v31, -v30, v30, v31
v_max_f32 v31, 0, v31
v_add_f32 v31, 0x3727c5ac, v31
v_rsq_f32 v31, v31
s_nop 0
v_mul_f32_e64 v30, -v30, v31
v_fma_f32 v40, v40, v31, v30
v_fma_f32 v41, v41, v31, v30
v_fma_f32 v42, v42, v31, v30
v_fma_f32 v43, v43, v31, v30
v_fma_f32 v44, v44, v31, v30
v_fma_f32 v45, v45, v31, v30
v_fma_f32 v46, v46, v31, v30
v_fma_f32 v47, v47, v31, v30
v_cvt_pk_bf16_f32 v24, v40, v41
v_cvt_pk_bf16_f32 v25, v42, v43
v_cvt_pk_bf16_f32 v26, v44, v45
v_cvt_pk_bf16_f32 v27, v46, v47
v_cndmask_b32 v8, 0, v24, s[60:61]
v_cndmask_b32 v9, 0, v25, s[60:61]
v_cndmask_b32 v10, 0, v26, s[60:61]
v_cndmask_b32 v11, 0, v27, s[60:61]
v_cndmask_b32 v12, 0, v24, s[62:63]
v_cndmask_b32 v13, 0, v25, s[62:63]
v_cndmask_b32 v14, 0, v26, s[62:63]
v_cndmask_b32 v15, 0, v27, s[62:63]
v_cndmask_b32 v16, 0, v24, s[64:65]
v_cndmask_b32 v17, 0, v25, s[64:65]
v_cndmask_b32 v18, 0, v26, s[64:65]
v_cndmask_b32 v19, 0, v27, s[64:65]
v_cndmask_b32 v20, 0, v24, s[66:67]
v_cndmask_b32 v21, 0, v25, s[66:67]
v_cndmask_b32 v22, 0, v26, s[66:67]
v_cndmask_b32 v23, 0, v27, s[66:67]
s_waitcnt vmcnt(0)
ds_write_b32 v6, v6 offset:32
W_3:
ds_read_b128 v[56:59], v1 offset:32
ds_read_b64_tr_b16 v[40:41], v36 offset:0
ds_read_b64_tr_b16 v[42:43], v36 offset:2048
ds_read_b64_tr_b16 v[44:45], v36 offset:4096
ds_read_b64_tr_b16 v[46:47], v36 offset:6144
ds_read_b64_tr_b16 v[48:49], v36 offset:8192
ds_read_b64_tr_b16 v[50:51], v36 offset:10240
ds_read_b64_tr_b16 v[52:53], v36 offset:12288
ds_read_b64_tr_b16 v[54:55], v36 offset:14336
s_waitcnt lgkmcnt(0)
v_min_u32 v56, v56, v57
v_min3_u32 v56, v56, v58, v59
v_cmp_le_u32 vcc, 1, v56
s_cbranch_vccnz D_4
s_add_u32 s34, s34, 1
s_cmp_lt_u32 s34, 2097152
s_cbranch_scc0 L_done
s_branch W_3
D_4:
v_mfma_f32_16x16x32_bf16 v[56:59], v[40:43], v[8:11], 0
v_mfma_f32_16x16x32_bf16 v[56:59], v[44:47], v[12:15], v[56:59]
v_mfma_f32_16x16x32_bf16 v[56:59], v[48:51], v[16:19], v[56:59]
v_mfma_f32_16x16x32_bf16 v[56:59], v[52:55], v[20:23], v[56:59]
s_nop 7
v_add_f32_dpp v56, v56, v56 row_ror:4 row_mask:0xf bank_mask:0xf
v_add_f32_dpp v57, v57, v57 row_ror:4 row_mask:0xf bank_mask:0xf
v_add_f32_dpp v58, v58, v58 row_ror:4 row_mask:0xf bank_mask:0xf
v_add_f32_dpp v59, v59, v59 row_ror:4 row_mask:0xf bank_mask:0xf
v_add_f32_dpp v56, v56, v56 row_ror:8 row_mask:0xf bank_mask:0xf
v_add_f32_dpp v57, v57, v57 row_ror:8 row_mask:0xf bank_mask:0xf
v_add_f32_dpp v58, v58, v58 row_ror:8 row_mask:0xf bank_mask:0xf
v_add_f32_dpp v59, v59, v59 row_ror:8 row_mask:0xf bank_mask:0xf
v_cvt_pk_bf16_f32 v60, v56, v57
v_cvt_pk_bf16_f32 v62, v58, v59
s_waitcnt vmcnt(0)
s_mov_b64 exec, s[60:61]
buffer_store_dwordx4 v[60:63], v37, s[36:39], s55 offen sc1
s_mov_b64 exec, -1
ds_write_b32 v6, v6 offset:384
s_cmp_ge_u32 s4, 16
s_cbranch_scc1 L_rlo
L_att:
s_mov_b32 s48, s10
s_and_b32 s49, s11, 0xffff
s_mov_b32 s50, 16777216
s_mov_b32 s51, 0x20000
s_lshl_b32 s58, s3, 4
s_add_u32 s58, s58, s4
s_lshl_b32 s52, s58, 17
s_cmp_lt_u32 s5, 6
s_cbranch_scc1 L_a0
s_and_b32 s6, s5, 1
s_lshl_b32 s6, s6, 14
s_add_u32 s53, s52, s6
s_mov_b32 m0, s6
v_xor_b32 v8, 0, v7
buffer_load_dwordx4 v8, s[48:51], s53 offen nt lds
s_add_u32 m0, m0, 1024
s_add_u32 s53, s53, 1024
v_xor_b32 v9, 64, v7
buffer_load_dwordx4 v9, s[48:51], s53 offen nt lds
s_add_u32 m0, m0, 1024
s_add_u32 s53, s53, 1024
v_xor_b32 v8, 128, v7
buffer_load_dwordx4 v8, s[48:51], s53 offen nt lds
s_add_u32 m0, m0, 1024
s_add_u32 s53, s53, 1024
v_xor_b32 v9, 192, v7
buffer_load_dwordx4 v9, s[48:51], s53 offen nt lds
s_add_u32 m0, m0, 1024
s_add_u32 s53, s53, 1024
v_xor_b32 v8, 16, v7
buffer_load_dwordx4 v8, s[48:51], s53 offen nt lds
s_add_u32 m0, m0, 1024
s_add_u32 s53, s53, 1024
v_xor_b32 v9, 80, v7
buffer_load_dwordx4 v9, s[48:51], s53 offen nt lds
s_add_u32 m0, m0, 1024
s_add_u32 s53, s53, 1024
v_xor_b32 v8, 144, v7
buffer_load_dwordx4 v8, s[48:51], s53 offen nt lds
s_add_u32 m0, m0, 1024
s_add_u32 s53, s53, 1024
v_xor_b32 v9, 208, v7
buffer_load_dwordx4 v9, s[48:51], s53 offen nt lds
s_add_u32 m0, m0, 1024
s_add_u32 s53, s53, 1024
v_xor_b32 v8, 32, v7
buffer_load_dwordx4 v8, s[48:51], s53 offen nt lds
s_add_u32 m0, m0, 1024
s_add_u32 s53, s53, 1024
v_xor_b32 v9, 96, v7
buffer_load_dwordx4 v9, s[48:51], s53 offen nt lds
s_add_u32 m0, m0, 1024
s_add_u32 s53, s53, 1024
v_xor_b32 v8, 160, v7
buffer_load_dwordx4 v8, s[48:51], s53 offen nt lds
s_add_u32 m0, m0, 1024
s_add_u32 s53, s53, 1024
v_xor_b32 v9, 224, v7
buffer_load_dwordx4 v9, s[48:51], s53 offen nt lds
s_add_u32 m0, m0, 1024
s_add_u32 s53, s53, 1024
v_xor_b32 v8, 48, v7
buffer_load_dwordx4 v8, s[48:51], s53 offen nt lds
s_add_u32 m0, m0, 1024
s_add_u32 s53, s53, 1024
v_xor_b32 v9, 112, v7
buffer_load_dwordx4 v9, s[48:51], s53 offen nt lds
s_add_u32 m0, m0, 1024
s_add_u32 s53, s53, 1024
v_xor_b32 v8, 176, v7
buffer_load_dwordx4 v8, s[48:51], s53 offen nt lds
s_add_u32 m0, m0, 1024
s_add_u32 s53, s53, 1024
v_xor_b32 v9, 240, v7
buffer_load_dwordx4 v9, s[48:51], s53 offen nt lds
s_add_u32 m0, m0, 1024
s_add_u32 s53, s53, 1024
L_a0:
s_and_b32 s54, s5, 3
s_lshr_b32 s55, s5, 2
s_lshl_b32 s6, s54, 14
v_lshl_or_b32 v24, v2, 2, v3
v_lshlrev_b32 v24, 4, v24
v_lshl_add_u32 v24, v4, 8, v24
v_lshl_add_u32 v24, v5, 10, v24
v_add_u32 v24, s6, v24
v_lshrrev_b32 v25, 5, v0
v_and_b32 v26, 1, v4
v_xor_b32 v26, v26, v25
v_lshlrev_b32 v26, 1, v26
v_lshrrev_b32 v27, 1, v2
v_or_b32 v26, v26, v27
v_lshl_or_b32 v26, v3, 2, v26
v_lshlrev_b32 v26, 4, v26
v_and_b32 v27, 1, v2
v_lshl_add_u32 v26, v27, 3, v26
v_lshl_add_u32 v27, v25, 3, v3
v_lshl_add_u32 v26, v27, 10, v26
s_lshl_b32 s6, s5, 7
v_xor_b32 v56, s6, v26
v_xor_b32 v57, 16, v56
v_xor_b32 v58, 64, v56
v_xor_b32 v59, 80, v56
v_lshlrev_b32 v28, 4, v5
v_lshl_add_u32 v28, v4, 8, v28
v_lshl_add_u32 v28, v5, 10, v28
s_lshl_b32 s6, s55, 14
s_add_u32 s6, s6, 0
v_add_u32 v28, s6, v28
v_xor_b32 v8, 0, v28
v_xor_b32 v9, 16, v28
v_xor_b32 v10, 32, v28
v_xor_b32 v11, 48, v28
v_xor_b32 v12, 64, v28
v_xor_b32 v13, 80, v28
v_xor_b32 v14, 96, v28
v_xor_b32 v15, 112, v28
v_xor_b32 v16, 128, v28
v_xor_b32 v17, 144, v28
v_xor_b32 v18, 160, v28
v_xor_b32 v19, 176, v28
v_xor_b32 v20, 192, v28
v_xor_b32 v21, 208, v28
v_xor_b32 v22, 224, v28
v_xor_b32 v23, 240, v28
s_lshl_b32 s6, s55, 8
v_lshl_add_u32 v28, v5, 4, v1
v_add_u32 v28, s6, v28
s_lshl_b32 s7, s54, 2
v_add_u32 v27, s7, v28
v_and_b32 v29, 31, v0
v_lshl_add_u32 v29, v29, 2, v1
s_lshl_b32 s7, s55, 6
v_lshl_add_u32 v60, v5, 2, v1
v_add_u32 v60, s7, v60
v_lshl_add_u32 v61, v25, 4, v1
v_lshlrev_b32 v30, 9, v25
v_and_b32 v40, 1, v4
v_lshl_add_u32 v30, v40, 3, v30
v_lshl_add_u32 v30, v5, 4, v30
s_lshl_b32 s7, s54, 10
s_add_u32 s6, s6, s7
s_add_u32 s6, s6, 131072
v_add_u32 v30, s6, v30
v_lshlrev_b32 v26, 12, v25
v_lshl_add_u32 v26, v40, 10, v26
v_bfe_u32 v40, v0, 3, 1
v_lshl_add_u32 v26, v40, 11, v26
v_and_b32 v40, 7, v0
v_lshl_add_u32 v26, v40, 4, v26
v_add_u32 v25, 131072, v7
s_lshl_b32 s30, s58, 9
s_add_u32 s30, s30, 7340032
s_lshl_b32 s31, s54, 19
s_lshl_b32 s6, s58, 10
s_add_u32 s31, s31, s6
s_add_u32 s31, s31, 262144
s_lshl_b32 s58, s58, 15
s_lshl_b32 s6, s5, 7
s_add_u32 s58, s58, s6
s_add_u32 s58, s58, 16777216
s_mov_b32 s56, 0x3e0293ee
s_mov_b32 s57, 0x3f803f80
v_mov_b32 v52, -1
v_mov_b32 v53, -1
v_mov_b32 v54, -1
v_mov_b32 v55, -1
s_and_b32 s6, s4, 1
s_cmp_lg_u32 s6, 0
s_cselect_b32 s40, s24, s22
s_cselect_b32 s41, s25, s23
s_cselect_b32 s44, s22, s24
s_cselect_b32 s45, s23, s25
s_cselect_b32 s21, 0x8000, 0
s_and_b32 s41, s41, 0xffff
s_and_b32 s45, s45, 0xffff
s_mov_b32 s42, 1835008
s_mov_b32 s43, 0x20000
s_mov_b32 s46, 1835008
s_mov_b32 s47, 0x20000
s_lshl_b32 s59, s3, 3
s_and_b32 s6, s4, 7
s_add_u32 s59, s59, s6
v_lshl_add_u32 v63, v4, 3, v3
v_mul_u32_u24 v63, 3584, v63
v_and_b32 v62, 1, v4
v_lshlrev_b32 v62, 1, v62
v_xor_b32 v62, v62, v2
v_lshl_add_u32 v62, v62, 4, v63
v_add_u32 v63, 14336, v62
s_lshl_b32 s59, s59, 6
s_and_b32 s7, s5, 3
s_mul_i32 s6, s7, 458752
s_add_u32 s59, s59, s6
s_lshl_b32 s7, s7, 13
s_add_u32 s21, s21, s7
s_lshr_b32 s20, s4, 3
s_lshr_b32 s6, s5, 2
s_and_b32 s20, s20, s6
s_cmp_eq_u32 s3, 7
s_cselect_b32 s20, 0, s20
s_cmp_lt_u32 s5, 4
s_cbranch_scc1 L_alo
s_cmp_lt_u32 s5, 6
s_cbranch_scc1 L_ald
s_waitcnt vmcnt(0)
ds_write_b32 v6, v6 offset:96
s_mov_b32 s53, 4096
buffer_load_dwordx4 v[44:47], v7, s[36:39], s53 offen sc1
W_5:
ds_read_b128 v[40:43], v1 offset:112
s_waitcnt lgkmcnt(0)
v_min_u32 v40, v40, v41
v_min3_u32 v40, v40, v42, v43
v_cmp_le_u32 vcc, 1, v40
s_cbranch_vccnz D_6
s_add_u32 s34, s34, 1
s_cmp_lt_u32 s34, 2097152
s_cbranch_scc0 L_done
s_sleep 2
s_branch W_5
D_6:
v_xor_b32 v40, 0, v24
ds_read_b128 v[128:131], v40
v_xor_b32 v41, 16, v24
ds_read_b128 v[132:135], v41
v_xor_b32 v40, 32, v24
ds_read_b128 v[136:139], v40
v_xor_b32 v41, 48, v24
ds_read_b128 v[140:143], v41
v_xor_b32 v40, 64, v24
ds_read_b128 v[144:147], v40
v_xor_b32 v41, 80, v24
ds_read_b128 v[148:151], v41
v_xor_b32 v40, 96, v24
ds_read_b128 v[152:155], v40
v_xor_b32 v41, 112, v24
ds_read_b128 v[156:159], v41
v_xor_b32 v40, 128, v24
ds_read_b128 v[160:163], v40
v_xor_b32 v41, 144, v24
ds_read_b128 v[164:167], v41
v_xor_b32 v40, 160, v24
ds_read_b128 v[168:171], v40
v_xor_b32 v41, 176, v24
ds_read_b128 v[172:175], v41
s_waitcnt lgkmcnt(4)
v_xor_b32 v40, 192, v24
ds_read_b128 v[176:179], v40
v_xor_b32 v41, 208, v24
ds_read_b128 v[180:183], v41
v_xor_b32 v40, 224, v24
ds_read_b128 v[184:187], v40
v_xor_b32 v41, 240, v24
ds_read_b128 v[188:191], v41
ds_read_b64_tr_b16 v[192:193], v56 offset:0
ds_read_b64_tr_b16 v[194:195], v57 offset:4096
ds_read_b64_tr_b16 v[208:209], v58 offset:0
ds_read_b64_tr_b16 v[210:211], v59 offset:4096
s_waitcnt lgkmcnt(2)
ds_read_b64_tr_b16 v[196:197], v56 offset:16384
ds_read_b64_tr_b16 v[198:199], v57 offset:20480
ds_read_b64_tr_b16 v[212:213], v58 offset:16384
ds_read_b64_tr_b16 v[214:215], v59 offset:20480
ds_read_b64_tr_b16 v[200:201], v56 offset:32768
ds_read_b64_tr_b16 v[202:203], v57 offset:36864
ds_read_b64_tr_b16 v[216:217], v58 offset:32768
ds_read_b64_tr_b16 v[218:219], v59 offset:36864
ds_read_b64_tr_b16 v[204:205], v56 offset:49152
ds_read_b64_tr_b16 v[206:207], v57 offset:53248
ds_read_b64_tr_b16 v[220:221], v58 offset:49152
ds_read_b64_tr_b16 v[222:223], v59 offset:53248
v_add_u32 v24, 0x10000, v24
v_add_u32 v56, 0x10000, v56
v_add_u32 v57, 0x10000, v57
v_add_u32 v58, 0x10000, v58
v_add_u32 v59, 0x10000, v59
s_waitcnt lgkmcnt(0)
ds_write_b32 v6, v6 offset:256
s_cmp_lg_u32 s5, 7
s_cbranch_scc1 L_a1
s_add_u32 s69, s69, 1
s_mul_i32 s68, s69, 0x9e3779b1
s_branch PC_9
PR_7:
buffer_load_dwordx4 v[44:47], v7, s[36:39], s53 offen sc1
PC_9:
s_waitcnt vmcnt(0)
v_xor_b32 v44, s68, v44
v_xor_b32 v46, s68, v46
v_or_b32 v44, v44, v46
v_cmp_ne_u32 vcc, 0, v44
s_cbranch_vccz PD_8
s_add_u32 s34, s34, 1
s_cmp_lt_u32 s34, 2097152
s_cbranch_scc0 L_done
s_sleep 4
s_branch PR_7
PD_8:
s_getreg_b32 s7, hwreg(HW_REG_XCC_ID)
v_xor_b32 v45, s7, v45
v_xor_b32 v47, s7, v47
v_or_b32 v45, v45, v47
v_lshrrev_b32 v46, 3, v0
v_cmp_eq_u32 vcc, s3, v46
s_nop 1
v_cndmask_b32 v45, 0, v45, vcc
v_cmp_ne_u32 vcc, 0, v45
s_cmp_eq_u64 vcc, 0
s_cselect_b32 s6, 2, 1
v_mov_b32 v46, s6
ds_write_b32 v1, v46 offset:352
W_10:
ds_read_b32 v40, v1 offset:352
s_waitcnt lgkmcnt(0)
v_cmp_le_u32 vcc, 1, v40
s_cbranch_vccnz D_11
s_add_u32 s34, s34, 1
s_cmp_lt_u32 s34, 2097152
s_cbranch_scc0 L_done
s_sleep 4
s_branch W_10
D_11:
v_readfirstlane_b32 s35, v40
s_nop 0
s_sub_u32 s35, s35, 1
s_lshl_b32 s53, s3, 12
s_and_b32 s7, s4, 15
s_lshl_b32 s7, s7, 7
s_add_u32 s53, s53, s7
s_add_u32 s53, s53, 1769472
v_mov_b32 v40, 0
v_mov_b32 v41, s68
s_mov_b64 exec, 1
s_cmp_eq_u32 s35, 1
s_cbranch_scc1 SL_12
buffer_store_dword v41, v40, s[36:39], s53 offen sc1
s_branch SE_13
SL_12:
buffer_store_dword v41, v40, s[36:39], s53 offen
SE_13:
buffer_store_dword v41, v40, s[36:39], s53 offen offset:2048 sc1
s_mov_b64 exec, -1
L_a1:
s_waitcnt vmcnt(0)
s_mov_b32 s7, s58
buffer_store_dwordx4 v[52:55], v26, s[36:39], s7 offen sc1
s_add_u32 s7, s7, 8192
buffer_store_dwordx4 v[52:55], v26, s[36:39], s7 offen sc1
s_add_u32 s7, s7, 8192
buffer_store_dwordx4 v[52:55], v26, s[36:39], s7 offen sc1
s_add_u32 s7, s7, 8192
buffer_store_dwordx4 v[52:55], v26, s[36:39], s7 offen sc1
s_cmp_lt_u32 s5, 4
s_cbranch_scc1 L_nc_14
buffer_store_dwordx4 v[52:55], v7, s[36:39], s31 offen sc1
L_nc_14:
s_branch L_as
L_ald:
v_xor_b32 v224, 0, v7
v_xor_b32 v225, 64, v7
v_add_u32 v225, 1024, v225
v_xor_b32 v226, 128, v7
v_add_u32 v226, 2048, v226
v_xor_b32 v227, 192, v7
v_add_u32 v227, 3072, v227
v_xor_b32 v228, 16, v7
v_add_u32 v228, 4096, v228
v_xor_b32 v229, 80, v7
v_add_u32 v229, 5120, v229
v_xor_b32 v230, 144, v7
v_add_u32 v230, 6144, v230
v_xor_b32 v231, 208, v7
v_add_u32 v231, 7168, v231
v_xor_b32 v232, 32, v7
v_add_u32 v232, 8192, v232
v_xor_b32 v233, 96, v7
v_add_u32 v233, 9216, v233
v_xor_b32 v234, 160, v7
v_add_u32 v234, 10240, v234
v_xor_b32 v235, 224, v7
v_add_u32 v235, 11264, v235
v_xor_b32 v236, 48, v7
v_add_u32 v236, 12288, v236
v_xor_b32 v237, 112, v7
v_add_u32 v237, 13312, v237
v_xor_b32 v238, 176, v7
v_add_u32 v238, 14336, v238
v_xor_b32 v239, 240, v7
v_add_u32 v239, 15360, v239
s_lshl_b32 s6, s54, 14
s_add_u32 s6, s6, 0x8000
s_mov_b32 m0, s6
s_add_u32 s53, s52, s6
W_15:
ds_read_b128 v[40:43], v1 offset:384
s_waitcnt lgkmcnt(0)
v_min_u32 v40, v40, v41
v_min3_u32 v40, v40, v42, v43
v_cmp_le_u32 vcc, 1, v40
s_cbranch_vccnz D_16
s_add_u32 s34, s34, 1
s_cmp_lt_u32 s34, 2097152
s_cbranch_scc0 L_done
s_sleep 1
s_branch W_15
D_16:
buffer_load_dwordx4 v224, s[48:51], s53 offen nt lds
s_add_u32 m0, m0, 1024
s_nop 0
buffer_load_dwordx4 v225, s[48:51], s53 offen nt lds
s_add_u32 m0, m0, 1024
s_nop 0
buffer_load_dwordx4 v226, s[48:51], s53 offen nt lds
s_add_u32 m0, m0, 1024
s_nop 0
buffer_load_dwordx4 v227, s[48:51], s53 offen nt lds
s_add_u32 m0, m0, 1024
s_nop 0
buffer_load_dwordx4 v228, s[48:51], s53 offen nt lds
s_add_u32 m0, m0, 1024
s_nop 0
buffer_load_dwordx4 v229, s[48:51], s53 offen nt lds
s_add_u32 m0, m0, 1024
s_nop 0
buffer_load_dwordx4 v230, s[48:51], s53 offen nt lds
s_add_u32 m0, m0, 1024
s_nop 0
buffer_load_dwordx4 v231, s[48:51], s53 offen nt lds
s_add_u32 m0, m0, 1024
s_nop 0
buffer_load_dwordx4 v232, s[48:51], s53 offen nt lds
s_add_u32 m0, m0, 1024
s_nop 0
buffer_load_dwordx4 v233, s[48:51], s53 offen nt lds
s_add_u32 m0, m0, 1024
s_nop 0
buffer_load_dwordx4 v234, s[48:51], s53 offen nt lds
s_add_u32 m0, m0, 1024
s_nop 0
buffer_load_dwordx4 v235, s[48:51], s53 offen nt lds
s_add_u32 m0, m0, 1024
s_nop 0
buffer_load_dwordx4 v236, s[48:51], s53 offen nt lds
s_add_u32 m0, m0, 1024
s_nop 0
buffer_load_dwordx4 v237, s[48:51], s53 offen nt lds
s_add_u32 m0, m0, 1024
s_nop 0
buffer_load_dwordx4 v238, s[48:51], s53 offen nt lds
s_add_u32 m0, m0, 1024
s_nop 0
buffer_load_dwordx4 v239, s[48:51], s53 offen nt lds
s_add_u32 m0, m0, 17408
s_add_u32 s53, s53, 32768
buffer_load_dwordx4 v224, s[48:51], s53 offen nt lds
s_add_u32 m0, m0, 1024
s_nop 0
buffer_load_dwordx4 v225, s[48:51], s53 offen nt lds
s_add_u32 m0, m0, 1024
s_nop 0
buffer_load_dwordx4 v226, s[48:51], s53 offen nt lds
s_add_u32 m0, m0, 1024
s_nop 0
buffer_load_dwordx4 v227, s[48:51], s53 offen nt lds
s_add_u32 m0, m0, 1024
s_nop 0
buffer_load_dwordx4 v228, s[48:51], s53 offen nt lds
s_add_u32 m0, m0, 1024
s_nop 0
buffer_load_dwordx4 v229, s[48:51], s53 offen nt lds
s_add_u32 m0, m0, 1024
s_nop 0
buffer_load_dwordx4 v230, s[48:51], s53 offen nt lds
s_add_u32 m0, m0, 1024
s_nop 0
buffer_load_dwordx4 v231, s[48:51], s53 offen nt lds
s_add_u32 m0, m0, 1024
s_nop 0
buffer_load_dwordx4 v232, s[48:51], s53 offen nt lds
s_add_u32 m0, m0, 1024
s_nop 0
buffer_load_dwordx4 v233, s[48:51], s53 offen nt lds
s_add_u32 m0, m0, 1024
s_nop 0
buffer_load_dwordx4 v234, s[48:51], s53 offen nt lds
s_add_u32 m0, m0, 1024
s_nop 0
buffer_load_dwordx4 v235, s[48:51], s53 offen nt lds
s_add_u32 m0, m0, 1024
s_nop 0
buffer_load_dwordx4 v236, s[48:51], s53 offen nt lds
s_add_u32 m0, m0, 1024
s_waitcnt vmcnt(28)
buffer_load_dwordx4 v237, s[48:51], s53 offen nt lds
s_add_u32 m0, m0, 1024
s_waitcnt vmcnt(28)
buffer_load_dwordx4 v238, s[48:51], s53 offen nt lds
s_add_u32 m0, m0, 1024
s_waitcnt vmcnt(28)
buffer_load_dwordx4 v239, s[48:51], s53 offen nt lds
s_add_u32 m0, m0, 17408
s_add_u32 s53, s53, 32768
s_waitcnt vmcnt(28)
buffer_load_dwordx4 v224, s[48:51], s53 offen nt lds
s_add_u32 m0, m0, 1024
s_waitcnt vmcnt(28)
buffer_load_dwordx4 v225, s[48:51], s53 offen nt lds
s_add_u32 m0, m0, 1024
s_waitcnt vmcnt(28)
buffer_load_dwordx4 v226, s[48:51], s53 offen nt lds
s_add_u32 m0, m0, 1024
s_waitcnt vmcnt(28)
buffer_load_dwordx4 v227, s[48:51], s53 offen nt lds
s_add_u32 m0, m0, 1024
s_waitcnt vmcnt(28)
s_waitcnt vmcnt(20)
ds_write_b32 v6, v6 offset:96
W_17:
ds_read_b128 v[40:43], v1 offset:112
s_waitcnt lgkmcnt(0)
v_min_u32 v40, v40, v41
v_min3_u32 v40, v40, v42, v43
v_cmp_le_u32 vcc, 1, v40
s_cbranch_vccnz D_18
s_add_u32 s34, s34, 1
s_cmp_lt_u32 s34, 2097152
s_cbranch_scc0 L_done
s_sleep 2
s_branch W_17
D_18:
v_xor_b32 v40, 0, v24
ds_read_b128 v[128:131], v40
v_xor_b32 v41, 16, v24
ds_read_b128 v[132:135], v41
v_xor_b32 v40, 32, v24
ds_read_b128 v[136:139], v40
v_xor_b32 v41, 48, v24
ds_read_b128 v[140:143], v41
v_xor_b32 v40, 64, v24
ds_read_b128 v[144:147], v40
v_xor_b32 v41, 80, v24
ds_read_b128 v[148:151], v41
v_xor_b32 v40, 96, v24
ds_read_b128 v[152:155], v40
v_xor_b32 v41, 112, v24
ds_read_b128 v[156:159], v41
v_xor_b32 v40, 128, v24
ds_read_b128 v[160:163], v40
v_xor_b32 v41, 144, v24
ds_read_b128 v[164:167], v41
v_xor_b32 v40, 160, v24
ds_read_b128 v[168:171], v40
v_xor_b32 v41, 176, v24
ds_read_b128 v[172:175], v41
s_waitcnt lgkmcnt(4)
v_xor_b32 v40, 192, v24
ds_read_b128 v[176:179], v40
v_xor_b32 v41, 208, v24
ds_read_b128 v[180:183], v41
v_xor_b32 v40, 224, v24
ds_read_b128 v[184:187], v40
v_xor_b32 v41, 240, v24
ds_read_b128 v[188:191], v41
ds_read_b64_tr_b16 v[192:193], v56 offset:0
ds_read_b64_tr_b16 v[194:195], v57 offset:4096
ds_read_b64_tr_b16 v[208:209], v58 offset:0
ds_read_b64_tr_b16 v[210:211], v59 offset:4096
s_waitcnt lgkmcnt(2)
ds_read_b64_tr_b16 v[196:197], v56 offset:16384
ds_read_b64_tr_b16 v[198:199], v57 offset:20480
ds_read_b64_tr_b16 v[212:213], v58 offset:16384
ds_read_b64_tr_b16 v[214:215], v59 offset:20480
ds_read_b64_tr_b16 v[200:201], v56 offset:32768
ds_read_b64_tr_b16 v[202:203], v57 offset:36864
ds_read_b64_tr_b16 v[216:217], v58 offset:32768
ds_read_b64_tr_b16 v[218:219], v59 offset:36864
ds_read_b64_tr_b16 v[204:205], v56 offset:49152
ds_read_b64_tr_b16 v[206:207], v57 offset:53248
ds_read_b64_tr_b16 v[220:221], v58 offset:49152
ds_read_b64_tr_b16 v[222:223], v59 offset:53248
v_add_u32 v24, 0x10000, v24
v_add_u32 v56, 0x10000, v56
v_add_u32 v57, 0x10000, v57
v_add_u32 v58, 0x10000, v58
v_add_u32 v59, 0x10000, v59
s_waitcnt lgkmcnt(0)
ds_write_b32 v6, v6 offset:256
s_mov_b32 s7, s58
buffer_store_dwordx4 v[52:55], v26, s[36:39], s7 offen sc1
s_add_u32 s7, s7, 8192
buffer_store_dwordx4 v[52:55], v26, s[36:39], s7 offen sc1
s_add_u32 s7, s7, 8192
buffer_store_dwordx4 v[52:55], v26, s[36:39], s7 offen sc1
s_add_u32 s7, s7, 8192
buffer_store_dwordx4 v[52:55], v26, s[36:39], s7 offen sc1
s_cmp_lt_u32 s5, 4
s_cbranch_scc1 L_nc_19
buffer_store_dwordx4 v[52:55], v7, s[36:39], s31 offen sc1
L_nc_19:
s_waitcnt vmcnt(5)
ds_write_b32 v6, v6 offset:128
W_20:
ds_read_b128 v[40:43], v1 offset:128
s_waitcnt lgkmcnt(0)
v_min_u32 v40, v40, v41
v_min3_u32 v40, v40, v42, v43
v_cmp_le_u32 vcc, 1, v40
s_cbranch_vccnz D_21
s_add_u32 s34, s34, 1
s_cmp_lt_u32 s34, 2097152
s_cbranch_scc0 L_done
s_branch W_20
D_21:
buffer_load_dwordx4 v228, s[48:51], s53 offen nt lds
s_add_u32 m0, m0, 1024
s_nop 0
buffer_load_dwordx4 v229, s[48:51], s53 offen nt lds
s_add_u32 m0, m0, 1024
s_nop 0
buffer_load_dwordx4 v230, s[48:51], s53 offen nt lds
s_add_u32 m0, m0, 1024
s_nop 0
buffer_load_dwordx4 v231, s[48:51], s53 offen nt lds
s_add_u32 m0, m0, 1024
s_nop 0
buffer_load_dwordx4 v232, s[48:51], s53 offen nt lds
s_add_u32 m0, m0, 1024
s_nop 0
buffer_load_dwordx4 v233, s[48:51], s53 offen nt lds
s_add_u32 m0, m0, 1024
s_nop 0
buffer_load_dwordx4 v234, s[48:51], s53 offen nt lds
s_add_u32 m0, m0, 1024
s_nop 0
buffer_load_dwordx4 v235, s[48:51], s53 offen nt lds
s_add_u32 m0, m0, 1024
W_22:
ds_read_b128 v[40:43], v1 offset:192
s_waitcnt lgkmcnt(0)
v_min_u32 v40, v40, v41
v_min3_u32 v40, v40, v42, v43
v_cmp_le_u32 vcc, 1, v40
s_cbranch_vccnz D_23
s_add_u32 s34, s34, 1
s_cmp_lt_u32 s34, 2097152
s_cbranch_scc0 L_done
s_branch W_22
D_23:
buffer_load_dwordx4 v236, s[48:51], s53 offen nt lds
s_add_u32 m0, m0, 1024
s_nop 0
buffer_load_dwordx4 v237, s[48:51], s53 offen nt lds
s_add_u32 m0, m0, 1024
s_nop 0
buffer_load_dwordx4 v238, s[48:51], s53 offen nt lds
s_add_u32 m0, m0, 1024
s_nop 0
buffer_load_dwordx4 v239, s[48:51], s53 offen nt lds
s_add_u32 m0, m0, 17408
s_add_u32 s53, s53, 32768
s_branch L_as
L_alo:
s_and_b32 s6, s5, 1
s_lshl_b32 s6, s6, 7
v_xor_b32 v40, s6, v7
s_lshr_b32 s54, s3, 1
s_lshl_b32 s54, s54, 2
s_add_u32 s54, s54, s5
s_mul_i32 s54, s54, 270336
s_lshl_b32 s55, s5, 13
s_add_u32 s54, s54, 2105344
s_add_u32 s55, s55, 0
v_add_u32 v31, s55, v7
v_xor_b32 v44, 0, v40
v_xor_b32 v45, 16, v40
v_add_u32 v45, 1024, v45
v_xor_b32 v46, 32, v40
v_add_u32 v46, 2048, v46
v_xor_b32 v47, 48, v40
v_add_u32 v47, 3072, v47
v_xor_b32 v48, 64, v40
v_add_u32 v48, 4096, v48
v_xor_b32 v49, 80, v40
v_add_u32 v49, 5120, v49
v_xor_b32 v50, 96, v40
v_add_u32 v50, 6144, v50
v_xor_b32 v51, 112, v40
v_add_u32 v51, 7168, v51
W_24:
ds_read_b128 v[40:43], v1 offset:112
s_waitcnt lgkmcnt(0)
v_min_u32 v40, v40, v41
v_min3_u32 v40, v40, v42, v43
v_cmp_le_u32 vcc, 1, v40
s_cbranch_vccnz D_25
s_add_u32 s34, s34, 1
s_cmp_lt_u32 s34, 2097152
s_cbranch_scc0 L_done
s_sleep 2
s_branch W_24
D_25:
v_xor_b32 v40, 0, v24
ds_read_b128 v[128:131], v40
v_xor_b32 v41, 16, v24
ds_read_b128 v[132:135], v41
v_xor_b32 v40, 32, v24
ds_read_b128 v[136:139], v40
v_xor_b32 v41, 48, v24
ds_read_b128 v[140:143], v41
v_xor_b32 v40, 64, v24
ds_read_b128 v[144:147], v40
v_xor_b32 v41, 80, v24
ds_read_b128 v[148:151], v41
v_xor_b32 v40, 96, v24
ds_read_b128 v[152:155], v40
v_xor_b32 v41, 112, v24
ds_read_b128 v[156:159], v41
v_xor_b32 v40, 128, v24
ds_read_b128 v[160:163], v40
v_xor_b32 v41, 144, v24
ds_read_b128 v[164:167], v41
v_xor_b32 v40, 160, v24
ds_read_b128 v[168:171], v40
v_xor_b32 v41, 176, v24
ds_read_b128 v[172:175], v41
s_waitcnt lgkmcnt(4)
v_xor_b32 v40, 192, v24
ds_read_b128 v[176:179], v40
v_xor_b32 v41, 208, v24
ds_read_b128 v[180:183], v41
v_xor_b32 v40, 224, v24
ds_read_b128 v[184:187], v40
v_xor_b32 v41, 240, v24
ds_read_b128 v[188:191], v41
ds_read_b64_tr_b16 v[192:193], v56 offset:0
ds_read_b64_tr_b16 v[194:195], v57 offset:4096
ds_read_b64_tr_b16 v[208:209], v58 offset:0
ds_read_b64_tr_b16 v[210:211], v59 offset:4096
s_waitcnt lgkmcnt(2)
ds_read_b64_tr_b16 v[196:197], v56 offset:16384
ds_read_b64_tr_b16 v[198:199], v57 offset:20480
ds_read_b64_tr_b16 v[212:213], v58 offset:16384
ds_read_b64_tr_b16 v[214:215], v59 offset:20480
ds_read_b64_tr_b16 v[200:201], v56 offset:32768
ds_read_b64_tr_b16 v[202:203], v57 offset:36864
ds_read_b64_tr_b16 v[216:217], v58 offset:32768
ds_read_b64_tr_b16 v[218:219], v59 offset:36864
ds_read_b64_tr_b16 v[204:205], v56 offset:49152
ds_read_b64_tr_b16 v[206:207], v57 offset:53248
ds_read_b64_tr_b16 v[220:221], v58 offset:49152
ds_read_b64_tr_b16 v[222:223], v59 offset:53248
v_add_u32 v24, 0x10000, v24
v_add_u32 v56, 0x10000, v56
v_add_u32 v57, 0x10000, v57
v_add_u32 v58, 0x10000, v58
v_add_u32 v59, 0x10000, v59
s_waitcnt lgkmcnt(0)
ds_write_b32 v6, v6 offset:256
s_mov_b32 s7, s58
buffer_store_dwordx4 v[52:55], v26, s[36:39], s7 offen sc1
s_add_u32 s7, s7, 8192
buffer_store_dwordx4 v[52:55], v26, s[36:39], s7 offen sc1
s_add_u32 s7, s7, 8192
buffer_store_dwordx4 v[52:55], v26, s[36:39], s7 offen sc1
s_add_u32 s7, s7, 8192
buffer_store_dwordx4 v[52:55], v26, s[36:39], s7 offen sc1
s_cmp_lt_u32 s5, 4
s_cbranch_scc1 L_nc_26
buffer_store_dwordx4 v[52:55], v7, s[36:39], s31 offen sc1
L_nc_26:
W_27:
ds_read_b32 v40, v1 offset:352
s_waitcnt lgkmcnt(0)
v_cmp_le_u32 vcc, 1, v40
s_cbranch_vccnz D_28
s_add_u32 s34, s34, 1
s_cmp_lt_u32 s34, 2097152
s_cbranch_scc0 L_done
s_sleep 2
s_branch W_27
D_28:
W_29:
ds_read_b128 v[32:35], v1 offset:256
ds_read_b128 v[36:39], v1 offset:272
s_waitcnt lgkmcnt(0)
v_min_u32 v32, v32, v33
v_min3_u32 v32, v32, v34, v35
v_min3_u32 v32, v32, v36, v37
v_min3_u32 v32, v32, v38, v39
v_cmp_le_u32 vcc, 1, v32
s_cbranch_vccnz D_30
s_add_u32 s34, s34, 1
s_cmp_lt_u32 s34, 2097152
s_cbranch_scc0 L_done
s_sleep 1
s_branch W_29
D_30:
W_31:
ds_read_b64 v[40:41], v1 offset:144
s_waitcnt lgkmcnt(0)
v_min_u32 v40, v40, v41
v_cmp_le_u32 vcc, 1, v40
s_cbranch_vccnz D_32
s_add_u32 s34, s34, 1
s_cmp_lt_u32 s34, 2097152
s_cbranch_scc0 L_done
s_sleep 1
s_branch W_31
D_32:
s_mov_b32 m0, s55
s_nop 0
buffer_load_dwordx4 v44, s[36:39], s54 offen sc1 lds
s_add_u32 m0, m0, 1024
s_nop 0
buffer_load_dwordx4 v45, s[36:39], s54 offen sc1 lds
s_add_u32 m0, m0, 1024
s_nop 0
buffer_load_dwordx4 v46, s[36:39], s54 offen sc1 lds
s_add_u32 m0, m0, 1024
s_nop 0
buffer_load_dwordx4 v47, s[36:39], s54 offen sc1 lds
s_add_u32 m0, m0, 1024
s_nop 0
buffer_load_dwordx4 v48, s[36:39], s54 offen sc1 lds
s_add_u32 m0, m0, 1024
s_nop 0
buffer_load_dwordx4 v49, s[36:39], s54 offen sc1 lds
s_add_u32 m0, m0, 1024
s_nop 0
buffer_load_dwordx4 v50, s[36:39], s54 offen sc1 lds
s_add_u32 m0, m0, 1024
s_nop 0
buffer_load_dwordx4 v51, s[36:39], s54 offen sc1 lds
ds_write_b32 v6, v6 offset:128
PC_35:
s_waitcnt vmcnt(7)
ds_read_b128 v[64:67], v31 offset:0
s_waitcnt vmcnt(6)
ds_read_b128 v[68:71], v31 offset:1024
s_waitcnt vmcnt(5)
ds_read_b128 v[72:75], v31 offset:2048
s_waitcnt vmcnt(4)
ds_read_b128 v[76:79], v31 offset:3072
s_waitcnt vmcnt(3)
ds_read_b128 v[80:83], v31 offset:4096
s_waitcnt vmcnt(2)
ds_read_b128 v[84:87], v31 offset:5120
s_waitcnt vmcnt(1)
ds_read_b128 v[88:91], v31 offset:6144
s_waitcnt vmcnt(0)
ds_read_b128 v[92:95], v31 offset:7168
s_waitcnt lgkmcnt(0)
v_max3_u32 v40, v64, v65, v66
v_max3_u32 v40, v40, v67, v68
v_max3_u32 v40, v40, v69, v70
v_max3_u32 v40, v40, v71, v72
v_max3_u32 v40, v40, v73, v74
v_max3_u32 v40, v40, v75, v76
v_max3_u32 v40, v40, v77, v78
v_max3_u32 v40, v40, v79, v80
v_max3_u32 v40, v40, v81, v82
v_max3_u32 v40, v40, v83, v84
v_max3_u32 v40, v40, v85, v86
v_max3_u32 v40, v40, v87, v88
v_max3_u32 v40, v40, v89, v90
v_max3_u32 v40, v40, v91, v92
v_max3_u32 v40, v40, v93, v94
v_max_u32 v40, v40, v95
v_cmp_eq_u32 vcc, -1, v40
s_cbranch_vccz PD_34
s_add_u32 s34, s34, 1
s_cmp_lt_u32 s34, 2097152
s_cbranch_scc0 L_done
s_sleep 0
v_max3_u32 v40, v64, v65, v66
v_max_u32 v40, v40, v67
v_cmp_eq_u32 vcc, -1, v40
s_cbranch_vccz SK_36
s_add_u32 m0, s55, 0
s_nop 0
buffer_load_dwordx4 v44, s[36:39], s54 offen sc1 lds
SK_36:
v_max3_u32 v40, v68, v69, v70
v_max_u32 v40, v40, v71
v_cmp_eq_u32 vcc, -1, v40
s_cbranch_vccz SK_37
s_add_u32 m0, s55, 1024
s_nop 0
buffer_load_dwordx4 v45, s[36:39], s54 offen sc1 lds
SK_37:
v_max3_u32 v40, v72, v73, v74
v_max_u32 v40, v40, v75
v_cmp_eq_u32 vcc, -1, v40
s_cbranch_vccz SK_38
s_add_u32 m0, s55, 2048
s_nop 0
buffer_load_dwordx4 v46, s[36:39], s54 offen sc1 lds
SK_38:
v_max3_u32 v40, v76, v77, v78
v_max_u32 v40, v40, v79
v_cmp_eq_u32 vcc, -1, v40
s_cbranch_vccz SK_39
s_add_u32 m0, s55, 3072
s_nop 0
buffer_load_dwordx4 v47, s[36:39], s54 offen sc1 lds
SK_39:
v_max3_u32 v40, v80, v81, v82
v_max_u32 v40, v40, v83
v_cmp_eq_u32 vcc, -1, v40
s_cbranch_vccz SK_40
s_add_u32 m0, s55, 4096
s_nop 0
buffer_load_dwordx4 v48, s[36:39], s54 offen sc1 lds
SK_40:
v_max3_u32 v40, v84, v85, v86
v_max_u32 v40, v40, v87
v_cmp_eq_u32 vcc, -1, v40
s_cbranch_vccz SK_41
s_add_u32 m0, s55, 5120
s_nop 0
buffer_load_dwordx4 v49, s[36:39], s54 offen sc1 lds
SK_41:
v_max3_u32 v40, v88, v89, v90
v_max_u32 v40, v40, v91
v_cmp_eq_u32 vcc, -1, v40
s_cbranch_vccz SK_42
s_add_u32 m0, s55, 6144
s_nop 0
buffer_load_dwordx4 v50, s[36:39], s54 offen sc1 lds
SK_42:
v_max3_u32 v40, v92, v93, v94
v_max_u32 v40, v40, v95
v_cmp_eq_u32 vcc, -1, v40
s_cbranch_vccz SK_43
s_add_u32 m0, s55, 7168
s_nop 0
buffer_load_dwordx4 v51, s[36:39], s54 offen sc1 lds
SK_43:
s_waitcnt vmcnt(0)
s_branch PC_35
PD_34:
ds_write_b32 v6, v6 offset:192
L_as:
W_44:
ds_read_b128 v[40:43], v1 offset:192
s_waitcnt lgkmcnt(0)
v_min_u32 v40, v40, v41
v_min3_u32 v40, v40, v42, v43
v_cmp_le_u32 vcc, 1, v40
s_cbranch_vccnz D_45
s_add_u32 s34, s34, 1
s_cmp_lt_u32 s34, 2097152
s_cbranch_scc0 L_done
s_branch W_44
D_45:
ds_read_b128 v[64:67], v8
ds_read_b128 v[68:71], v9
ds_read_b128 v[72:75], v10
ds_read_b128 v[76:79], v11
ds_read_b128 v[80:83], v12
ds_read_b128 v[84:87], v13
ds_read_b128 v[88:91], v14
ds_read_b128 v[92:95], v15
ds_read_b128 v[96:99], v16
ds_read_b128 v[100:103], v17
ds_read_b128 v[104:107], v18
ds_read_b128 v[108:111], v19
ds_read_b128 v[112:115], v20
ds_read_b128 v[116:119], v21
ds_read_b128 v[120:123], v22
s_waitcnt lgkmcnt(14)
ds_read_b128 v[124:127], v23
v_mfma_f32_16x16x32_bf16 v[44:47], v[128:131], v[64:67], 0
s_waitcnt lgkmcnt(14)
v_mfma_f32_16x16x32_bf16 v[44:47], v[132:135], v[68:71], v[44:47]
s_waitcnt lgkmcnt(13)
v_mfma_f32_16x16x32_bf16 v[44:47], v[136:139], v[72:75], v[44:47]
s_waitcnt lgkmcnt(12)
v_mfma_f32_16x16x32_bf16 v[44:47], v[140:143], v[76:79], v[44:47]
s_waitcnt lgkmcnt(11)
v_mfma_f32_16x16x32_bf16 v[44:47], v[144:147], v[80:83], v[44:47]
s_waitcnt lgkmcnt(10)
v_mfma_f32_16x16x32_bf16 v[44:47], v[148:151], v[84:87], v[44:47]
s_waitcnt lgkmcnt(9)
v_mfma_f32_16x16x32_bf16 v[44:47], v[152:155], v[88:91], v[44:47]
s_waitcnt lgkmcnt(8)
v_mfma_f32_16x16x32_bf16 v[44:47], v[156:159], v[92:95], v[44:47]
s_waitcnt lgkmcnt(7)
v_mfma_f32_16x16x32_bf16 v[44:47], v[160:163], v[96:99], v[44:47]
s_waitcnt lgkmcnt(6)
v_mfma_f32_16x16x32_bf16 v[44:47], v[164:167], v[100:103], v[44:47]
s_waitcnt lgkmcnt(5)
v_mfma_f32_16x16x32_bf16 v[44:47], v[168:171], v[104:107], v[44:47]
s_waitcnt lgkmcnt(4)
v_mfma_f32_16x16x32_bf16 v[44:47], v[172:175], v[108:111], v[44:47]
s_waitcnt lgkmcnt(3)
v_mfma_f32_16x16x32_bf16 v[44:47], v[176:179], v[112:115], v[44:47]
s_waitcnt lgkmcnt(2)
v_mfma_f32_16x16x32_bf16 v[44:47], v[180:183], v[116:119], v[44:47]
s_waitcnt lgkmcnt(1)
v_mfma_f32_16x16x32_bf16 v[44:47], v[184:187], v[120:123], v[44:47]
s_waitcnt lgkmcnt(0)
v_mfma_f32_16x16x32_bf16 v[44:47], v[188:191], v[124:127], v[44:47]
s_nop 7
v_max3_f32 v48, v44, v45, v46
v_max_f32 v48, v48, v47
v_mov_b32 v49, v48
s_nop 1
v_permlane16_swap_b32 v48, v49
v_max_f32 v48, v48, v49
v_mov_b32 v49, v48
s_nop 1
v_permlane32_swap_b32 v48, v49
v_max_f32 v48, v48, v49
v_mul_f32 v48, s56, v48
ds_write_b32 v27, v48 offset:512
s_waitcnt lgkmcnt(0)
s_barrier
ds_read_b128 v[48:51], v28 offset:512
s_waitcnt lgkmcnt(0)
v_max3_f32 v32, v48, v49, v50
v_max_f32 v32, v32, v51
v_fma_f32 v44, v44, s56, -v32
v_fma_f32 v45, v45, s56, -v32
v_fma_f32 v46, v46, s56, -v32
v_fma_f32 v47, v47, s56, -v32
v_exp_f32 v44, v44
v_exp_f32 v45, v45
v_exp_f32 v46, v46
v_exp_f32 v47, v47
v_cvt_pk_bf16_f32 v44, v44, v45
v_cvt_pk_bf16_f32 v45, v46, v47
ds_write_b64 v30, v[44:45]
s_waitcnt vmcnt(0) lgkmcnt(0)
s_barrier
v_xor_b32 v40, 0, v24
ds_read_b128 v[128:131], v40
v_xor_b32 v41, 16, v24
ds_read_b128 v[132:135], v41
v_xor_b32 v40, 32, v24
ds_read_b128 v[136:139], v40
v_xor_b32 v41, 48, v24
ds_read_b128 v[140:143], v41
v_xor_b32 v40, 64, v24
ds_read_b128 v[144:147], v40
v_xor_b32 v41, 80, v24
ds_read_b128 v[148:151], v41
v_xor_b32 v40, 96, v24
ds_read_b128 v[152:155], v40
v_xor_b32 v41, 112, v24
ds_read_b128 v[156:159], v41
v_xor_b32 v40, 128, v24
ds_read_b128 v[160:163], v40
v_xor_b32 v41, 144, v24
ds_read_b128 v[164:167], v41
v_xor_b32 v40, 160, v24
ds_read_b128 v[168:171], v40
v_xor_b32 v41, 176, v24
ds_read_b128 v[172:175], v41
v_xor_b32 v40, 192, v24
ds_read_b128 v[176:179], v40
v_xor_b32 v41, 208, v24
ds_read_b128 v[180:183], v41
s_cmp_eq_u32 s20, 0
s_cbranch_scc1 L_nme
s_add_u32 m0, s21, 0
s_add_u32 s6, s59, 0
buffer_load_dwordx4 v62, s[40:43], s6 offen  lds
s_add_u32 m0, s21, 1024
s_add_u32 s6, s59, 0
buffer_load_dwordx4 v63, s[40:43], s6 offen  lds
s_add_u32 m0, s21, 2048
s_add_u32 s6, s59, 114688
buffer_load_dwordx4 v62, s[40:43], s6 offen  lds
L_nme:
s_waitcnt lgkmcnt(13)
v_xor_b32 v40, 224, v24
ds_read_b128 v[184:187], v40
v_mfma_f32_16x16x32_bf16 v[44:47], v[128:131], v[64:67], 0
s_waitcnt lgkmcnt(13)
v_xor_b32 v41, 240, v24
ds_read_b128 v[188:191], v41
v_mfma_f32_16x16x32_bf16 v[44:47], v[132:135], v[68:71], v[44:47]
s_waitcnt lgkmcnt(13)
ds_read_b128 v[8:11], v25 offset:0
v_mfma_f32_16x16x32_bf16 v[44:47], v[136:139], v[72:75], v[44:47]
s_waitcnt lgkmcnt(13)
ds_read_b128 v[12:15], v25 offset:1024
v_mfma_f32_16x16x32_bf16 v[44:47], v[140:143], v[76:79], v[44:47]
s_waitcnt lgkmcnt(13)
ds_read_b128 v[16:19], v25 offset:2048
v_mfma_f32_16x16x32_bf16 v[44:47], v[144:147], v[80:83], v[44:47]
s_waitcnt lgkmcnt(13)
ds_read_b128 v[20:23], v25 offset:3072
v_mfma_f32_16x16x32_bf16 v[44:47], v[148:151], v[84:87], v[44:47]
s_waitcnt lgkmcnt(13)
v_mfma_f32_16x16x32_bf16 v[44:47], v[152:155], v[88:91], v[44:47]
s_waitcnt lgkmcnt(12)
v_mfma_f32_16x16x32_bf16 v[44:47], v[156:159], v[92:95], v[44:47]
s_waitcnt lgkmcnt(11)
v_mfma_f32_16x16x32_bf16 v[44:47], v[160:163], v[96:99], v[44:47]
s_waitcnt lgkmcnt(10)
v_mfma_f32_16x16x32_bf16 v[44:47], v[164:167], v[100:103], v[44:47]
s_waitcnt lgkmcnt(9)
v_mfma_f32_16x16x32_bf16 v[44:47], v[168:171], v[104:107], v[44:47]
s_waitcnt lgkmcnt(8)
v_mfma_f32_16x16x32_bf16 v[44:47], v[172:175], v[108:111], v[44:47]
s_waitcnt lgkmcnt(7)
v_mfma_f32_16x16x32_bf16 v[44:47], v[176:179], v[112:115], v[44:47]
s_waitcnt lgkmcnt(6)
v_mfma_f32_16x16x32_bf16 v[44:47], v[180:183], v[116:119], v[44:47]
s_waitcnt lgkmcnt(5)
v_mfma_f32_16x16x32_bf16 v[44:47], v[184:187], v[120:123], v[44:47]
s_waitcnt lgkmcnt(4)
v_mfma_f32_16x16x32_bf16 v[44:47], v[188:191], v[124:127], v[44:47]
s_waitcnt lgkmcnt(0)
v_mfma_f32_32x32x16_bf16 v[224:239], v[8:11], v[192:195], 0
v_mfma_f32_32x32x16_bf16 v[240:255], v[8:11], v[208:211], 0
s_nop 4
v_max3_f32 v48, v44, v45, v46
v_max_f32 v48, v48, v47
v_mov_b32 v49, v48
s_nop 1
v_permlane16_swap_b32 v48, v49
v_max_f32 v48, v48, v49
v_mov_b32 v49, v48
s_nop 1
v_permlane32_swap_b32 v48, v49
v_max_f32 v48, v48, v49
v_mul_f32 v48, s56, v48
ds_write_b32 v27, v48 offset:1024
v_mfma_f32_32x32x16_bf16 v[224:239], v[12:15], v[196:199], v[224:239]
v_mfma_f32_32x32x16_bf16 v[240:255], v[12:15], v[212:215], v[240:255]
v_mfma_f32_32x32x16_bf16 v[224:239], v[16:19], v[200:203], v[224:239]
v_mfma_f32_32x32x16_bf16 v[240:255], v[16:19], v[216:219], v[240:255]
v_mfma_f32_32x32x16_bf16 v[224:239], v[20:23], v[204:207], v[224:239]
v_mfma_f32_32x32x16_bf16 v[240:255], v[20:23], v[220:223], v[240:255]
s_cmp_lg_u32 s5, 0
s_cbranch_scc1 L_nl1
v_dot2_f32_bf16 v34, v8, s57, 0
v_dot2_f32_bf16 v35, v9, s57, 0
v_dot2_f32_bf16 v34, v10, s57, v34
v_dot2_f32_bf16 v35, v11, s57, v35
v_dot2_f32_bf16 v34, v12, s57, v34
v_dot2_f32_bf16 v35, v13, s57, v35
v_dot2_f32_bf16 v34, v14, s57, v34
v_dot2_f32_bf16 v35, v15, s57, v35
v_dot2_f32_bf16 v34, v16, s57, v34
v_dot2_f32_bf16 v35, v17, s57, v35
v_dot2_f32_bf16 v34, v18, s57, v34
v_dot2_f32_bf16 v35, v19, s57, v35
v_dot2_f32_bf16 v34, v20, s57, v34
v_dot2_f32_bf16 v35, v21, s57, v35
v_dot2_f32_bf16 v34, v22, s57, v34
v_dot2_f32_bf16 v35, v23, s57, v35
L_nl1:
ds_read_b64_tr_b16 v[192:193], v56 offset:0
ds_read_b64_tr_b16 v[194:195], v57 offset:4096
ds_read_b64_tr_b16 v[208:209], v58 offset:0
ds_read_b64_tr_b16 v[210:211], v59 offset:4096
ds_read_b64_tr_b16 v[196:197], v56 offset:16384
ds_read_b64_tr_b16 v[198:199], v57 offset:20480
ds_read_b64_tr_b16 v[212:213], v58 offset:16384
ds_read_b64_tr_b16 v[214:215], v59 offset:20480
s_waitcnt lgkmcnt(0)
s_barrier
ds_read_b128 v[48:51], v28 offset:1024
ds_read_b64_tr_b16 v[200:201], v56 offset:32768
ds_read_b64_tr_b16 v[202:203], v57 offset:36864
ds_read_b64_tr_b16 v[216:217], v58 offset:32768
ds_read_b64_tr_b16 v[218:219], v59 offset:36864
ds_read_b64_tr_b16 v[204:205], v56 offset:49152
ds_read_b64_tr_b16 v[206:207], v57 offset:53248
ds_read_b64_tr_b16 v[220:221], v58 offset:49152
ds_read_b64_tr_b16 v[222:223], v59 offset:53248
s_waitcnt lgkmcnt(8)
v_max3_f32 v33, v48, v49, v50
v_max3_f32 v33, v33, v51, v32
v_sub_f32 v48, v32, v33
v_mov_b32 v32, v33
v_exp_f32 v48, v48
v_fma_f32 v44, v44, s56, -v32
v_fma_f32 v45, v45, s56, -v32
v_fma_f32 v46, v46, s56, -v32
v_fma_f32 v47, v47, s56, -v32
v_exp_f32 v44, v44
v_exp_f32 v45, v45
v_exp_f32 v46, v46
v_exp_f32 v47, v47
v_cvt_pk_bf16_f32 v44, v44, v45
v_cvt_pk_bf16_f32 v45, v46, v47
ds_write_b64 v30, v[44:45]
ds_write_b32 v60, v48 offset:1536
ds_write_b32 v60, v33 offset:1664
s_waitcnt lgkmcnt(0)
s_barrier
ds_read_b128 v[96:99], v25 offset:0
ds_read_b128 v[100:103], v25 offset:1024
ds_read_b128 v[104:107], v25 offset:2048
ds_read_b128 v[108:111], v25 offset:3072
ds_read_b128 v[112:115], v61 offset:1536
ds_read_b128 v[116:119], v61 offset:1568
ds_read_b128 v[120:123], v61 offset:1600
ds_read_b128 v[124:127], v61 offset:1632
s_cmp_lg_u32 s5, 7
s_cbranch_scc1 L_ncg
s_add_u32 s53, s53, 32768
v_mov_b32 v36, 0
v_mov_b32 v37, s68
s_mov_b64 exec, 1
s_cmp_eq_u32 s35, 1
s_cbranch_scc1 SL_46
buffer_store_dword v37, v36, s[36:39], s53 offen sc1
s_branch SE_47
SL_46:
buffer_store_dword v37, v36, s[36:39], s53 offen
SE_47:
buffer_store_dword v37, v36, s[36:39], s53 offen offset:2048 sc1
s_mov_b64 exec, -1
L_ncg:
s_cmp_lg_u32 s5, 0
s_cbranch_scc1 L_nl2
ds_read_b32 v48, v29 offset:1536
ds_read_b32 v40, v29 offset:1664
s_waitcnt lgkmcnt(6)
v_dot2_f32_bf16 v38, v96, s57, 0
v_dot2_f32_bf16 v39, v97, s57, 0
v_dot2_f32_bf16 v38, v98, s57, v38
v_dot2_f32_bf16 v39, v99, s57, v39
v_dot2_f32_bf16 v38, v100, s57, v38
v_dot2_f32_bf16 v39, v101, s57, v39
v_dot2_f32_bf16 v38, v102, s57, v38
v_dot2_f32_bf16 v39, v103, s57, v39
v_dot2_f32_bf16 v38, v104, s57, v38
v_dot2_f32_bf16 v39, v105, s57, v39
v_dot2_f32_bf16 v38, v106, s57, v38
v_dot2_f32_bf16 v39, v107, s57, v39
v_dot2_f32_bf16 v38, v108, s57, v38
v_dot2_f32_bf16 v39, v109, s57, v39
v_dot2_f32_bf16 v38, v110, s57, v38
v_dot2_f32_bf16 v39, v111, s57, v39
v_add_f32 v34, v34, v35
s_waitcnt lgkmcnt(0)
s_nop 0
v_add_f32 v38, v38, v39
v_fmac_f32 v38, v34, v48
v_mov_b32 v41, s68
v_mov_b32 v39, v38
v_mov_b32 v43, s68
s_nop 0
v_permlane32_swap_b32 v38, v39
v_add_f32 v42, v38, v39
s_mov_b32 exec_hi, 0
buffer_store_dwordx4 v[40:43], v7, s[36:39], s30 offen sc1
s_mov_b64 exec, -1
L_nl2:
s_waitcnt lgkmcnt(0)
v_pk_mul_f32 v[224:225], v[224:225], v[112:113]
v_pk_mul_f32 v[226:227], v[226:227], v[114:115]
v_pk_mul_f32 v[228:229], v[228:229], v[116:117]
v_pk_mul_f32 v[230:231], v[230:231], v[118:119]
v_pk_mul_f32 v[232:233], v[232:233], v[120:121]
v_pk_mul_f32 v[234:235], v[234:235], v[122:123]
v_pk_mul_f32 v[236:237], v[236:237], v[124:125]
v_pk_mul_f32 v[238:239], v[238:239], v[126:127]
v_pk_mul_f32 v[240:241], v[240:241], v[112:113]
v_pk_mul_f32 v[242:243], v[242:243], v[114:115]
v_pk_mul_f32 v[244:245], v[244:245], v[116:117]
v_pk_mul_f32 v[246:247], v[246:247], v[118:119]
v_pk_mul_f32 v[248:249], v[248:249], v[120:121]
v_pk_mul_f32 v[250:251], v[250:251], v[122:123]
v_pk_mul_f32 v[252:253], v[252:253], v[124:125]
v_pk_mul_f32 v[254:255], v[254:255], v[126:127]
v_mfma_f32_32x32x16_bf16 v[224:239], v[96:99], v[192:195], v[224:239]
s_nop 0
v_mfma_f32_32x32x16_bf16 v[240:255], v[96:99], v[208:211], v[240:255]
v_mfma_f32_32x32x16_bf16 v[224:239], v[100:103], v[196:199], v[224:239]
v_mfma_f32_32x32x16_bf16 v[240:255], v[100:103], v[212:215], v[240:255]
v_mfma_f32_32x32x16_bf16 v[224:239], v[104:107], v[200:203], v[224:239]
v_mfma_f32_32x32x16_bf16 v[240:255], v[104:107], v[216:219], v[240:255]
v_mfma_f32_32x32x16_bf16 v[224:239], v[108:111], v[204:207], v[224:239]
v_mfma_f32_32x32x16_bf16 v[240:255], v[108:111], v[220:223], v[240:255]
s_nop 11
v_cvt_pk_bf16_f32 v128, v224, v240
v_cvt_pk_bf16_f32 v129, v225, v241
v_cvt_pk_bf16_f32 v130, v226, v242
v_cvt_pk_bf16_f32 v131, v227, v243
v_min_u32 v128, -2, v128
v_min_u32 v129, -2, v129
v_min_u32 v130, -2, v130
v_min_u32 v131, -2, v131
v_cvt_pk_bf16_f32 v132, v228, v244
v_cvt_pk_bf16_f32 v133, v229, v245
v_cvt_pk_bf16_f32 v134, v230, v246
v_cvt_pk_bf16_f32 v135, v231, v247
v_min_u32 v132, -2, v132
v_min_u32 v133, -2, v133
v_min_u32 v134, -2, v134
v_min_u32 v135, -2, v135
v_permlane16_swap_b32 v128, v129
v_permlane16_swap_b32 v130, v131
v_mov_b32 v144, v128
v_mov_b32 v145, v129
v_cvt_pk_bf16_f32 v136, v232, v248
v_cvt_pk_bf16_f32 v137, v233, v249
v_cvt_pk_bf16_f32 v138, v234, v250
v_cvt_pk_bf16_f32 v139, v235, v251
v_min_u32 v136, -2, v136
v_min_u32 v137, -2, v137
v_min_u32 v138, -2, v138
v_min_u32 v139, -2, v139
v_permlane16_swap_b32 v132, v133
v_permlane16_swap_b32 v134, v135
v_mov_b32 v146, v132
v_mov_b32 v147, v133
v_mov_b32_dpp v128, v130 row_ror:8 row_mask:0xf bank_mask:0xc
v_mov_b32_dpp v129, v131 row_ror:8 row_mask:0xf bank_mask:0xc
v_mov_b32_dpp v130, v144 row_ror:8 row_mask:0xf bank_mask:0x3
v_mov_b32_dpp v131, v145 row_ror:8 row_mask:0xf bank_mask:0x3
buffer_store_dwordx4 v[128:131], v26, s[36:39], s58 offen sc1
s_add_u32 s58, s58, 8192
v_cvt_pk_bf16_f32 v140, v236, v252
v_cvt_pk_bf16_f32 v141, v237, v253
v_cvt_pk_bf16_f32 v142, v238, v254
v_cvt_pk_bf16_f32 v143, v239, v255
v_min_u32 v140, -2, v140
v_min_u32 v141, -2, v141
v_min_u32 v142, -2, v142
v_min_u32 v143, -2, v143
v_permlane16_swap_b32 v136, v137
v_permlane16_swap_b32 v138, v139
v_mov_b32 v148, v136
v_mov_b32 v149, v137
v_mov_b32_dpp v132, v134 row_ror:8 row_mask:0xf bank_mask:0xc
v_mov_b32_dpp v133, v135 row_ror:8 row_mask:0xf bank_mask:0xc
v_mov_b32_dpp v134, v146 row_ror:8 row_mask:0xf bank_mask:0x3
v_mov_b32_dpp v135, v147 row_ror:8 row_mask:0xf bank_mask:0x3
buffer_store_dwordx4 v[132:135], v26, s[36:39], s58 offen sc1
s_add_u32 s58, s58, 8192
v_permlane16_swap_b32 v140, v141
v_permlane16_swap_b32 v142, v143
v_mov_b32 v150, v140
v_mov_b32 v151, v141
v_mov_b32_dpp v136, v138 row_ror:8 row_mask:0xf bank_mask:0xc
v_mov_b32_dpp v137, v139 row_ror:8 row_mask:0xf bank_mask:0xc
v_mov_b32_dpp v138, v148 row_ror:8 row_mask:0xf bank_mask:0x3
v_mov_b32_dpp v139, v149 row_ror:8 row_mask:0xf bank_mask:0x3
buffer_store_dwordx4 v[136:139], v26, s[36:39], s58 offen sc1
s_add_u32 s58, s58, 8192
v_mov_b32_dpp v140, v142 row_ror:8 row_mask:0xf bank_mask:0xc
v_mov_b32_dpp v141, v143 row_ror:8 row_mask:0xf bank_mask:0xc
v_mov_b32_dpp v142, v150 row_ror:8 row_mask:0xf bank_mask:0x3
v_mov_b32_dpp v143, v151 row_ror:8 row_mask:0xf bank_mask:0x3
buffer_store_dwordx4 v[140:143], v26, s[36:39], s58 offen sc1
s_barrier
s_cmp_lt_u32 s4, 8
s_cbranch_scc1 L_a3
s_cmp_lg_u32 s3, 7
s_cbranch_scc1 L_mlp
L_a3:
s_cmp_ge_u32 s4, 4
s_cbranch_scc1 L_a4
s_cmp_ge_u32 s3, 4
s_cbranch_scc1 L_a4
s_cmp_eq_u32 s5, 0
s_cbranch_scc1 L_final
L_a4:
s_endpgm
L_rhi:
s_lshr_b32 s52, s4, 2
s_and_b32 s52, s52, 3
s_lshl_b32 s6, s3, 2
s_add_u32 s52, s52, s6
s_and_b32 s53, s4, 3
s_lshl_b32 s55, s52, 8
s_cmp_lt_u32 s5, 6
s_cbranch_scc1 L_r_nc
s_cmp_eq_u32 s5, 6
s_cbranch_scc1 L_r6
s_barrier
s_branch L_loader
L_r6:
v_mov_b32 v64, -1
v_mov_b32 v65, -1
v_mov_b32 v66, -1
v_mov_b32 v67, -1
s_lshl_b32 s58, s3, 4
s_add_u32 s58, s58, s4
s_sub_u32 s58, s58, 16
v_mul_u32_u24 v68, 1081344, v4
v_lshl_add_u32 v68, v5, 4, v68
s_and_b32 s6, s58, 31
s_lshl_b32 s6, s6, 8
s_lshr_b32 s7, s58, 5
s_mul_i32 s7, s7, 270336
s_add_u32 s6, s6, s7
s_add_u32 s6, s6, 2105344
buffer_store_dwordx4 v[64:67], v68, s[36:39], s6 offen sc1
s_barrier
s_getreg_b32 s59, hwreg(HW_REG_XCC_ID)
s_waitcnt lgkmcnt(0)
s_add_u32 s69, s69, 1
s_mul_i32 s68, s69, 0x9e3779b1
v_mov_b32 v12, s68
v_mov_b32 v13, s59
v_mov_b32 v14, 0
s_lshl_b32 s54, s58, 3
s_add_u32 s54, s54, 4096
s_waitcnt vmcnt(0)
s_mov_b64 exec, 1
buffer_store_dwordx2 v[12:13], v14, s[36:39], s54 offen sc1
s_mov_b64 exec, -1
ds_write_b32 v6, v6 offset:352
W_48:
ds_read_b64 v[20:21], v1 offset:208
s_waitcnt lgkmcnt(0)
v_min_u32 v20, v20, v21
v_cmp_le_u32 vcc, 1, v20
s_cbranch_vccnz D_49
s_add_u32 s34, s34, 1
s_cmp_lt_u32 s34, 2097152
s_cbranch_scc0 L_done
s_sleep 2
s_branch W_48
D_49:
s_mov_b32 s7, 4096
PR_50:
buffer_load_dwordx4 v[20:23], v7, s[36:39], s7 offen sc1
s_waitcnt vmcnt(0)
v_xor_b32 v20, v12, v20
v_xor_b32 v22, v12, v22
v_or_b32 v20, v20, v22
v_cmp_ne_u32 vcc, 0, v20
s_cbranch_vccz PD_51
s_add_u32 s34, s34, 1
s_cmp_lt_u32 s34, 2097152
s_cbranch_scc0 L_done
s_sleep 2
s_branch PR_50
PD_51:
v_xor_b32 v21, v13, v21
v_xor_b32 v23, v13, v23
v_or_b32 v21, v21, v23
v_lshrrev_b32 v22, 3, v0
v_cmp_eq_u32 vcc, s3, v22
s_nop 1
v_cndmask_b32 v21, 0, v21, vcc
v_cmp_ne_u32 vcc, 0, v21
s_cmp_eq_u64 vcc, 0
s_cselect_b32 s6, 2, 1
v_mov_b32 v22, s6
ds_write_b32 v1, v22 offset:352
s_waitcnt lgkmcnt(0)
s_branch L_role
L_r_nc:
s_mov_b32 s44, s14
s_and_b32 s45, s15, 0xffff
s_mov_b32 s46, 4194304
s_mov_b32 s47, 0x20000
v_xor_b32 v15, v5, v4
v_lshlrev_b32 v15, 4, v15
v_lshl_add_u32 v15, v4, 13, v15
s_lshl_b32 s54, s53, 20
s_add_u32 s54, s54, s55
s_lshl_b32 s56, s57, 19
s_add_u32 s54, s54, s56
s_lshl_b32 s56, s57, 14
s_add_u32 m0, s56, 98304
s_barrier
v_xor_b32 v16, 0, v15
buffer_load_dwordx4 v16, s[44:47], s54 offen nt lds
s_add_u32 m0, m0, 1024
s_add_u32 s54, s54, 32768
buffer_load_dwordx4 v16, s[44:47], s54 offen nt lds
s_add_u32 m0, m0, 1024
s_add_u32 s54, s54, 32768
v_xor_b32 v16, 64, v15
buffer_load_dwordx4 v16, s[44:47], s54 offen nt lds
s_add_u32 m0, m0, 1024
s_add_u32 s54, s54, 32768
buffer_load_dwordx4 v16, s[44:47], s54 offen nt lds
s_add_u32 m0, m0, 1024
s_add_u32 s54, s54, 32768
v_xor_b32 v16, 128, v15
buffer_load_dwordx4 v16, s[44:47], s54 offen nt lds
s_add_u32 m0, m0, 1024
s_add_u32 s54, s54, 32768
buffer_load_dwordx4 v16, s[44:47], s54 offen nt lds
s_add_u32 m0, m0, 1024
s_add_u32 s54, s54, 32768
v_xor_b32 v16, 192, v15
buffer_load_dwordx4 v16, s[44:47], s54 offen nt lds
s_add_u32 m0, m0, 1024
s_add_u32 s54, s54, 32768
buffer_load_dwordx4 v16, s[44:47], s54 offen nt lds
s_add_u32 m0, m0, 1024
s_add_u32 s54, s54, 32768
v_xor_b32 v16, 0, v15
buffer_load_dwordx4 v16, s[44:47], s54 offen nt lds
s_add_u32 m0, m0, 1024
s_add_u32 s54, s54, 32768
buffer_load_dwordx4 v16, s[44:47], s54 offen nt lds
s_add_u32 m0, m0, 1024
s_add_u32 s54, s54, 32768
v_xor_b32 v16, 64, v15
buffer_load_dwordx4 v16, s[44:47], s54 offen nt lds
s_add_u32 m0, m0, 1024
s_add_u32 s54, s54, 32768
buffer_load_dwordx4 v16, s[44:47], s54 offen nt lds
s_add_u32 m0, m0, 1024
s_add_u32 s54, s54, 32768
v_xor_b32 v16, 128, v15
buffer_load_dwordx4 v16, s[44:47], s54 offen nt lds
s_add_u32 m0, m0, 1024
s_add_u32 s54, s54, 32768
buffer_load_dwordx4 v16, s[44:47], s54 offen nt lds
s_add_u32 m0, m0, 1024
s_add_u32 s54, s54, 32768
v_xor_b32 v16, 192, v15
buffer_load_dwordx4 v16, s[44:47], s54 offen nt lds
s_add_u32 m0, m0, 1024
s_add_u32 s54, s54, 32768
buffer_load_dwordx4 v16, s[44:47], s54 offen nt lds
s_add_u32 m0, m0, 1024
s_add_u32 s54, s54, 32768
v_mul_u32_u24 v12, 1081344, v2
v_lshl_add_u32 v12, v3, 6, v12
v_lshl_add_u32 v12, v4, 4, v12
s_and_b32 s55, s52, 7
s_lshl_b32 s55, s55, 10
s_lshr_b32 s56, s52, 3
s_mul_i32 s56, s56, 270336
s_add_u32 s55, s55, s56
s_lshl_b32 s56, s53, 8
s_add_u32 s55, s55, s56
s_lshl_b32 s56, s57, 7
s_add_u32 s55, s55, s56
s_add_u32 s55, s55, 2105344
s_or_b64 s[70:71], s[60:61], s[62:63]
v_lshlrev_b32 v13, 4, v2
v_lshl_add_u32 v13, v3, 11, v13
v_lshl_add_u32 v13, v4, 7, v13
s_mul_i32 s56, s52, 135168
s_add_u32 s56, s56, 2097152
v_lshl_add_u32 v15, v3, 3, v2
v_lshlrev_b32 v15, 8, v15
v_xor_b32 v14, v2, v4
v_lshl_add_u32 v14, v3, 2, v14
v_lshl_add_u32 v16, v14, 4, v15
s_lshl_b32 s6, s57, 14
s_add_u32 s6, s6, 98304
v_add_u32 v16, s6, v16
v_xor_b32 v17, 64, v16
v_xor_b32 v18, 128, v16
v_xor_b32 v19, 192, v16
s_waitcnt lgkmcnt(0)
s_add_u32 s69, s69, 1
s_mul_i32 s68, s69, 0x9e3779b1
v_mov_b32 v8, s68
W_52:
ds_read_b128 v[20:23], v1 offset:160
s_waitcnt lgkmcnt(0)
v_min_u32 v20, v20, v21
v_min3_u32 v20, v20, v22, v23
v_cmp_le_u32 vcc, 1, v20
s_cbranch_vccnz D_53
s_add_u32 s34, s34, 1
s_cmp_lt_u32 s34, 2097152
s_cbranch_scc0 L_done
s_branch W_52
D_53:
buffer_load_dwordx4 v[24:27], v13, s[36:39], s56 offen offset:0 sc1
buffer_load_dwordx4 v[28:31], v13, s[36:39], s56 offen offset:64 sc1
buffer_load_dwordx4 v[32:35], v13, s[36:39], s56 offen offset:512 sc1
buffer_load_dwordx4 v[36:39], v13, s[36:39], s56 offen offset:576 sc1
buffer_load_dwordx4 v[40:43], v13, s[36:39], s56 offen offset:1024 sc1
buffer_load_dwordx4 v[44:47], v13, s[36:39], s56 offen offset:1088 sc1
buffer_load_dwordx4 v[48:51], v13, s[36:39], s56 offen offset:1536 sc1
buffer_load_dwordx4 v[52:55], v13, s[36:39], s56 offen offset:1600 sc1
s_waitcnt vmcnt(8)
ds_write_b32 v6, v6 offset:64
ds_read_b128 v[64:67], v16 offset:0
ds_read_b128 v[68:71], v17 offset:0
ds_read_b128 v[72:75], v18 offset:0
ds_read_b128 v[76:79], v19 offset:0
ds_read_b128 v[80:83], v16 offset:1024
ds_read_b128 v[84:87], v17 offset:1024
ds_read_b128 v[88:91], v18 offset:1024
ds_read_b128 v[92:95], v19 offset:1024
s_waitcnt lgkmcnt(4)
ds_read_b128 v[96:99], v16 offset:8192
ds_read_b128 v[100:103], v17 offset:8192
ds_read_b128 v[104:107], v18 offset:8192
ds_read_b128 v[108:111], v19 offset:8192
ds_read_b128 v[112:115], v16 offset:9216
ds_read_b128 v[116:119], v17 offset:9216
ds_read_b128 v[120:123], v18 offset:9216
ds_read_b128 v[124:127], v19 offset:9216
W_54:
ds_read_b32 v20, v1 offset:376
s_waitcnt lgkmcnt(0)
v_cmp_le_u32 vcc, 1, v20
s_cbranch_vccnz D_55
s_add_u32 s34, s34, 1
s_cmp_lt_u32 s34, 2097152
s_cbranch_scc0 L_done
s_branch W_54
D_55:
s_branch PC_58
PH1_56:
buffer_load_dwordx4 v[24:27], v13, s[36:39], s56 offen offset:0 sc1
buffer_load_dwordx4 v[28:31], v13, s[36:39], s56 offen offset:64 sc1
buffer_load_dwordx4 v[32:35], v13, s[36:39], s56 offen offset:512 sc1
buffer_load_dwordx4 v[36:39], v13, s[36:39], s56 offen offset:576 sc1
buffer_load_dwordx4 v[40:43], v13, s[36:39], s56 offen offset:1024 sc1
buffer_load_dwordx4 v[44:47], v13, s[36:39], s56 offen offset:1088 sc1
buffer_load_dwordx4 v[48:51], v13, s[36:39], s56 offen offset:1536 sc1
buffer_load_dwordx4 v[52:55], v13, s[36:39], s56 offen offset:1600 sc1
PC_58:
s_waitcnt vmcnt(0)
v_xor_b32 v21, v8, v25
v_xor_b32 v22, v8, v27
v_bitop3_b32 v21, v21, v29, v8 bitop3:0xf6
v_bitop3_b32 v22, v22, v31, v8 bitop3:0xf6
v_bitop3_b32 v21, v21, v33, v8 bitop3:0xf6
v_bitop3_b32 v22, v22, v35, v8 bitop3:0xf6
v_bitop3_b32 v21, v21, v37, v8 bitop3:0xf6
v_bitop3_b32 v22, v22, v39, v8 bitop3:0xf6
v_bitop3_b32 v21, v21, v41, v8 bitop3:0xf6
v_bitop3_b32 v22, v22, v43, v8 bitop3:0xf6
v_bitop3_b32 v21, v21, v45, v8 bitop3:0xf6
v_bitop3_b32 v22, v22, v47, v8 bitop3:0xf6
v_bitop3_b32 v21, v21, v49, v8 bitop3:0xf6
v_bitop3_b32 v22, v22, v51, v8 bitop3:0xf6
v_bitop3_b32 v21, v21, v53, v8 bitop3:0xf6
v_bitop3_b32 v22, v22, v55, v8 bitop3:0xf6
v_or_b32 v21, v21, v22
v_cmp_ne_u32 vcc, 0, v21
s_cbranch_vccz PD_57
s_add_u32 s34, s34, 1
s_cmp_lt_u32 s34, 2097152
s_cbranch_scc0 L_done
s_sleep 1
s_branch PH1_56
PD_57:
v_mov_b32 v25, v26
v_mov_b32 v26, v28
v_mov_b32 v27, v30
s_nop 1
v_mfma_f32_16x16x32_bf16 v[128:131], v[64:67], v[24:27], 0
v_mfma_f32_16x16x32_bf16 v[132:135], v[80:83], v[24:27], 0
v_mfma_f32_16x16x32_bf16 v[136:139], v[96:99], v[24:27], 0
v_mfma_f32_16x16x32_bf16 v[140:143], v[112:115], v[24:27], 0
v_mov_b32 v33, v34
v_mov_b32 v34, v36
v_mov_b32 v35, v38
s_nop 1
v_mfma_f32_16x16x32_bf16 v[128:131], v[68:71], v[32:35], v[128:131]
v_mfma_f32_16x16x32_bf16 v[132:135], v[84:87], v[32:35], v[132:135]
v_mfma_f32_16x16x32_bf16 v[136:139], v[100:103], v[32:35], v[136:139]
v_mfma_f32_16x16x32_bf16 v[140:143], v[116:119], v[32:35], v[140:143]
v_mov_b32 v41, v42
v_mov_b32 v42, v44
v_mov_b32 v43, v46
s_nop 1
v_mfma_f32_16x16x32_bf16 v[128:131], v[72:75], v[40:43], v[128:131]
v_mfma_f32_16x16x32_bf16 v[132:135], v[88:91], v[40:43], v[132:135]
v_mfma_f32_16x16x32_bf16 v[136:139], v[104:107], v[40:43], v[136:139]
v_mfma_f32_16x16x32_bf16 v[140:143], v[120:123], v[40:43], v[140:143]
v_mov_b32 v49, v50
v_mov_b32 v50, v52
v_mov_b32 v51, v54
s_nop 1
v_mfma_f32_16x16x32_bf16 v[128:131], v[76:79], v[48:51], v[128:131]
v_mfma_f32_16x16x32_bf16 v[132:135], v[92:95], v[48:51], v[132:135]
v_mfma_f32_16x16x32_bf16 v[136:139], v[108:111], v[48:51], v[136:139]
v_mfma_f32_16x16x32_bf16 v[140:143], v[124:127], v[48:51], v[140:143]
s_nop 4
v_add_f32_dpp v128, v128, v128 row_ror:8 row_mask:0xf bank_mask:0xf
v_add_f32_dpp v129, v129, v129 row_ror:8 row_mask:0xf bank_mask:0xf
v_add_f32_dpp v130, v130, v130 row_ror:8 row_mask:0xf bank_mask:0xf
v_add_f32_dpp v131, v131, v131 row_ror:8 row_mask:0xf bank_mask:0xf
v_add_f32_dpp v132, v132, v132 row_ror:8 row_mask:0xf bank_mask:0xf
v_add_f32_dpp v133, v133, v133 row_ror:8 row_mask:0xf bank_mask:0xf
v_add_f32_dpp v134, v134, v134 row_ror:8 row_mask:0xf bank_mask:0xf
v_add_f32_dpp v135, v135, v135 row_ror:8 row_mask:0xf bank_mask:0xf
v_add_f32_dpp v136, v136, v136 row_ror:8 row_mask:0xf bank_mask:0xf
v_add_f32_dpp v137, v137, v137 row_ror:8 row_mask:0xf bank_mask:0xf
v_add_f32_dpp v138, v138, v138 row_ror:8 row_mask:0xf bank_mask:0xf
v_add_f32_dpp v139, v139, v139 row_ror:8 row_mask:0xf bank_mask:0xf
v_add_f32_dpp v140, v140, v140 row_ror:8 row_mask:0xf bank_mask:0xf
v_add_f32_dpp v141, v141, v141 row_ror:8 row_mask:0xf bank_mask:0xf
v_add_f32_dpp v142, v142, v142 row_ror:8 row_mask:0xf bank_mask:0xf
v_add_f32_dpp v143, v143, v143 row_ror:8 row_mask:0xf bank_mask:0xf
v_add_f32_dpp v128, v128, v128 row_ror:4 row_mask:0xf bank_mask:0x1
v_add_f32_dpp v129, v129, v129 row_ror:4 row_mask:0xf bank_mask:0x1
v_add_f32_dpp v130, v130, v130 row_ror:4 row_mask:0xf bank_mask:0x1
v_add_f32_dpp v131, v131, v131 row_ror:4 row_mask:0xf bank_mask:0x1
v_add_f32_dpp v132, v132, v132 row_ror:4 row_mask:0xf bank_mask:0x1
v_add_f32_dpp v133, v133, v133 row_ror:4 row_mask:0xf bank_mask:0x1
v_add_f32_dpp v134, v134, v134 row_ror:4 row_mask:0xf bank_mask:0x1
v_add_f32_dpp v135, v135, v135 row_ror:4 row_mask:0xf bank_mask:0x1
v_add_f32_dpp v128, v136, v136 row_ror:4 row_mask:0xf bank_mask:0x2
v_add_f32_dpp v129, v137, v137 row_ror:4 row_mask:0xf bank_mask:0x2
v_add_f32_dpp v130, v138, v138 row_ror:4 row_mask:0xf bank_mask:0x2
v_add_f32_dpp v131, v139, v139 row_ror:4 row_mask:0xf bank_mask:0x2
v_add_f32_dpp v132, v140, v140 row_ror:4 row_mask:0xf bank_mask:0x2
v_add_f32_dpp v133, v141, v141 row_ror:4 row_mask:0xf bank_mask:0x2
v_add_f32_dpp v134, v142, v142 row_ror:4 row_mask:0xf bank_mask:0x2
v_add_f32_dpp v135, v143, v143 row_ror:4 row_mask:0xf bank_mask:0x2
s_mov_b64 exec, s[70:71]
v_cvt_pk_bf16_f32 v144, v128, v129
v_cvt_pk_bf16_f32 v145, v130, v131
v_cvt_pk_bf16_f32 v146, v132, v133
v_cvt_pk_bf16_f32 v147, v134, v135
v_min_u32 v144, -2, v144
v_min_u32 v145, -2, v145
v_min_u32 v146, -2, v146
v_min_u32 v147, -2, v147
buffer_store_dwordx4 v[144:147], v12, s[36:39], s55 offen sc1
s_mov_b64 exec, -1
s_waitcnt vmcnt(0)
ds_write_b32 v6, v6 offset:192
s_branch L_role
L_loader:
s_mov_b32 s40, s16
s_and_b32 s41, s17, 0xffff
s_mov_b32 s42, 4194304
s_mov_b32 s43, 0x20000
s_mov_b32 s44, s18
s_and_b32 s45, s19, 0xffff
s_mov_b32 s46, 4194304
s_mov_b32 s47, 0x20000
v_lshlrev_b32 v10, 2, v4
v_xor_b32 v10, v10, v5
v_lshlrev_b32 v10, 4, v10
v_and_b32 v11, 1, v4
v_lshl_add_u32 v10, v11, 18, v10
v_lshrrev_b32 v11, 5, v0
v_lshl_add_u32 v10, v11, 17, v10
s_lshl_b32 s54, s53, 20
s_add_u32 s54, s54, s55
v_lshl_add_u32 v24, v19, 10, v9
v_add_u32 v25, 16384, v24
v_add_u32 v26, 4096, v24
v_add_u32 v27, 20480, v24
s_lshl_b32 s58, s3, 19
s_and_b32 s55, s4, 7
s_lshl_b32 s55, s55, 7
s_add_u32 s58, s58, s55
s_mov_b32 s59, 0
s_waitcnt lgkmcnt(0)
s_add_u32 s69, s69, 1
s_mul_i32 s68, s69, 0x9e3779b1
W_59:
ds_read_b64 v[20:21], v1 offset:208
s_waitcnt lgkmcnt(0)
v_min_u32 v20, v20, v21
v_cmp_le_u32 vcc, 1, v20
s_cbranch_vccnz D_60
s_add_u32 s34, s34, 1
s_cmp_lt_u32 s34, 2097152
s_cbranch_scc0 L_done
s_sleep 2
s_branch W_59
D_60:
s_cmp_ge_u32 s4, 24
s_cbranch_scc1 L_ld_g0
s_lshl_b32 s6, s59, 12
s_add_u32 m0, s6, 32768
WO_61:
s_nop 0
buffer_load_dwordx4 v24, s[44:47], s58 offen nt lds
s_add_u32 m0, m0, 1024
s_waitcnt vmcnt(16)
buffer_load_dwordx4 v25, s[44:47], s58 offen nt lds
s_add_u32 m0, m0, 1024
s_waitcnt vmcnt(16)
buffer_load_dwordx4 v26, s[44:47], s58 offen nt lds
s_add_u32 m0, m0, 1024
s_waitcnt vmcnt(16)
buffer_load_dwordx4 v27, s[44:47], s58 offen nt lds
s_add_u32 m0, m0, 1024
s_waitcnt vmcnt(16)
s_add_u32 s58, s58, 32768
s_add_u32 s59, s59, 1
s_cmp_lt_u32 s59, 8
s_cbranch_scc1 WO_61
L_ld_g0:
W_62:
ds_read_b32 v20, v1 offset:352
s_waitcnt lgkmcnt(0)
v_cmp_le_u32 vcc, 1, v20
s_cbranch_vccnz D_63
s_add_u32 s34, s34, 1
s_cmp_lt_u32 s34, 2097152
s_cbranch_scc0 L_done
s_sleep 4
s_branch W_62
D_63:
v_readfirstlane_b32 s35, v20
s_nop 0
s_sub_u32 s35, s35, 1
s_lshl_b32 s7, s3, 12
s_add_u32 s7, s7, 1769472
s_cmp_eq_u32 s35, 1
s_cselect_b32 s6, 7, 7
v_and_b32 v20, 15, v0
v_lshlrev_b32 v20, s6, v20
s_cselect_b32 s6, 0, 2048
s_add_u32 s7, s7, s6
DB_64:
buffer_load_dword v21, v20, s[36:39], s7 offen sc1
s_waitcnt vmcnt(0)
v_cmp_ne_u32 vcc, s68, v21
s_cbranch_vccz PD_65
s_add_u32 s34, s34, 1
s_cmp_lt_u32 s34, 2097152
s_cbranch_scc0 L_done
s_sleep 4
s_branch DB_64
PD_65:
s_mov_b32 m0, 0
s_mov_b32 s57, 0
L_ld_uv:
s_add_u32 s56, s54, 0
buffer_load_dwordx4 v10, s[40:43], s56 offen nt lds
s_add_u32 m0, m0, 1024
s_waitcnt vmcnt(48)
s_add_u32 s56, s54, 8192
buffer_load_dwordx4 v10, s[40:43], s56 offen nt lds
s_add_u32 m0, m0, 1024
s_waitcnt vmcnt(48)
s_add_u32 s56, s54, 16384
buffer_load_dwordx4 v10, s[40:43], s56 offen nt lds
s_add_u32 m0, m0, 1024
s_waitcnt vmcnt(48)
s_add_u32 s56, s54, 24576
buffer_load_dwordx4 v10, s[40:43], s56 offen nt lds
s_add_u32 m0, m0, 1024
s_waitcnt vmcnt(48)
s_add_u32 s56, s54, 65536
buffer_load_dwordx4 v10, s[40:43], s56 offen nt lds
s_add_u32 m0, m0, 1024
s_waitcnt vmcnt(48)
s_add_u32 s56, s54, 73728
buffer_load_dwordx4 v10, s[40:43], s56 offen nt lds
s_add_u32 m0, m0, 1024
s_waitcnt vmcnt(48)
s_add_u32 s56, s54, 81920
buffer_load_dwordx4 v10, s[40:43], s56 offen nt lds
s_add_u32 m0, m0, 1024
s_waitcnt vmcnt(48)
s_add_u32 s56, s54, 90112
buffer_load_dwordx4 v10, s[40:43], s56 offen nt lds
s_add_u32 m0, m0, 1024
s_waitcnt vmcnt(48)
s_add_u32 s57, s57, 1
s_add_u32 s54, s54, 32768
s_cmp_eq_u32 s57, 2
s_cbranch_scc0 L_ld_uv2
s_add_u32 s54, s54, 458752
L_ld_uv2:
s_cmp_lt_u32 s57, 4
s_cbranch_scc1 L_ld_uv
s_cmp_ge_u32 s4, 24
s_cbranch_scc1 L_ld_none
s_lshl_b32 s6, s59, 12
s_add_u32 m0, s6, 32768
WO_66:
s_cmp_lg_u32 s59, 20
s_cbranch_scc1 UV_67
v_mov_b32 v14, 1
ds_write_b32 v1, v14 offset:356
UV_67:
buffer_load_dwordx4 v24, s[44:47], s58 offen nt lds
s_add_u32 m0, m0, 1024
s_waitcnt vmcnt(48)
buffer_load_dwordx4 v25, s[44:47], s58 offen nt lds
s_add_u32 m0, m0, 1024
s_waitcnt vmcnt(48)
buffer_load_dwordx4 v26, s[44:47], s58 offen nt lds
s_add_u32 m0, m0, 1024
s_waitcnt vmcnt(48)
buffer_load_dwordx4 v27, s[44:47], s58 offen nt lds
s_add_u32 m0, m0, 1024
s_waitcnt vmcnt(48)
s_add_u32 s58, s58, 32768
s_add_u32 s59, s59, 1
s_cmp_lt_u32 s59, 16
s_cbranch_scc1 WO_66
s_waitcnt vmcnt(32)
v_mov_b32 v14, 1
ds_write_b32 v1, v14 offset:356
L_ld_none:
s_waitcnt vmcnt(0)
v_mov_b32 v14, 2
ds_write_b32 v1, v14 offset:356
L_role:
s_and_b32 s30, s5, 3
s_mov_b32 s64, 0x0f000f00
s_mov_b32 s65, 0x0f000f00
s_mov_b32 s66, 0xf000f000
s_mov_b32 s67, 0xf000f000
s_cmp_lt_u32 s4, 24
s_cbranch_scc1 L_p5
s_waitcnt lgkmcnt(0)
s_endpgm
L_rlo:
s_lshr_b32 s52, s4, 2
s_and_b32 s52, s52, 3
s_lshl_b32 s6, s3, 2
s_add_u32 s52, s52, s6
s_and_b32 s53, s4, 3
v_and_b32 v9, 7, v0
v_lshl_add_u32 v9, v4, 3, v9
s_lshl_b32 s54, s5, 14
s_lshl_b32 s6, s52, 4
v_lshlrev_b32 v9, 9, v9
s_add_u32 s54, s54, s6
s_add_u32 s54, s54, 7340032
s_lshl_b32 s55, s5, 20
s_lshl_b32 s6, s52, 10
s_add_u32 s55, s55, s6
s_lshl_b32 s6, s53, 8
s_add_u32 s55, s55, s6
s_add_u32 s55, s55, 16777216
v_lshlrev_b32 v11, 18, v4
v_lshl_add_u32 v11, v5, 4, v11
v_and_b32 v14, 1, v0
v_lshlrev_b32 v14, 4, v14
v_mov_b32 v15, 0xffff
v_lshlrev_b32 v14, v14, v15
v_lshrrev_b32 v15, 1, v5
v_cmp_eq_u32 vcc, 0, v15
s_nop 1
v_cndmask_b32 v36, 0, v14, vcc
v_cmp_eq_u32 vcc, 1, v15
s_nop 1
v_cndmask_b32 v37, 0, v14, vcc
v_cmp_eq_u32 vcc, 2, v15
s_nop 1
v_cndmask_b32 v38, 0, v14, vcc
v_cmp_eq_u32 vcc, 3, v15
s_nop 1
v_cndmask_b32 v39, 0, v14, vcc
v_lshlrev_b32 v12, 4, v5
v_lshl_add_u32 v12, v4, 3, v12
s_mul_i32 s6, s5, 272
s_add_u32 s6, s6, 155136
v_add_u32 v12, s6, v12
v_mul_u32_u24 v13, 272, v2
v_lshl_add_u32 v13, v4, 4, v13
v_add_u32 v13, v13, v1
v_xor_b32 v14, s5, v3
v_lshlrev_b32 v14, 6, v14
v_lshrrev_b32 v15, 2, v0
v_lshl_add_u32 v14, v15, 8, v14
v_lshl_add_u32 v14, v2, 4, v14
v_lshlrev_b32 v15, 8, v4
v_lshl_add_u32 v15, v2, 4, v15
s_lshl_b32 s56, s52, 12
s_lshl_b32 s6, s5, 10
s_add_u32 s56, s56, s6
s_lshl_b32 s6, s53, 6
s_add_u32 s56, s56, s6
s_add_u32 s56, s56, 262144
s_waitcnt vmcnt(0)
ds_write_b32 v6, v6 offset:160
W_68:
ds_read_b32 v35, v1 offset:352
s_waitcnt lgkmcnt(0)
v_cmp_le_u32 vcc, 1, v35
s_cbranch_vccnz D_69
s_add_u32 s34, s34, 1
s_cmp_lt_u32 s34, 2097152
s_cbranch_scc0 L_done
s_sleep 4
s_branch W_68
D_69:
v_readfirstlane_b32 s35, v35
s_nop 0
s_sub_u32 s35, s35, 1
W_70:
ds_read_b32 v35, v1 offset:356
s_waitcnt lgkmcnt(0)
v_cmp_le_u32 vcc, 1, v35
s_cbranch_vccnz D_71
s_add_u32 s34, s34, 1
s_cmp_lt_u32 s34, 2097152
s_cbranch_scc0 L_done
s_sleep 4
s_branch W_70
D_71:
ds_read_b64_tr_b16 v[224:225], v14 offset:0
ds_read_b64_tr_b16 v[226:227], v14 offset:4096
ds_read_b64_tr_b16 v[228:229], v14 offset:8192
ds_read_b64_tr_b16 v[230:231], v14 offset:12288
ds_read_b64_tr_b16 v[232:233], v14 offset:16384
ds_read_b64_tr_b16 v[234:235], v14 offset:20480
ds_read_b64_tr_b16 v[236:237], v14 offset:24576
ds_read_b64_tr_b16 v[238:239], v14 offset:28672
s_waitcnt lgkmcnt(0)
ds_read_b64_tr_b16 v[240:241], v14 offset:8
ds_read_b64_tr_b16 v[242:243], v14 offset:4104
ds_read_b64_tr_b16 v[244:245], v14 offset:8200
ds_read_b64_tr_b16 v[246:247], v14 offset:12296
ds_read_b64_tr_b16 v[248:249], v14 offset:16392
ds_read_b64_tr_b16 v[250:251], v14 offset:20488
ds_read_b64_tr_b16 v[252:253], v14 offset:24584
ds_read_b64_tr_b16 v[254:255], v14 offset:28680
s_waitcnt lgkmcnt(0)
s_cmp_lg_u32 s5, 0
s_cbranch_scc1 L_cg1
s_lshl_b32 s7, s3, 12
s_add_u32 s7, s7, 1802240
s_cmp_eq_u32 s35, 1
s_cselect_b32 s6, 7, 7
v_and_b32 v16, 15, v0
v_lshlrev_b32 v16, s6, v16
s_cselect_b32 s6, 0, 2048
s_add_u32 s7, s7, s6
DB_72:
buffer_load_dword v17, v16, s[36:39], s7 offen sc1
s_waitcnt vmcnt(0)
v_cmp_ne_u32 vcc, s68, v17
s_cbranch_vccz PD_73
s_add_u32 s34, s34, 1
s_cmp_lt_u32 s34, 2097152
s_cbranch_scc0 L_done
s_sleep 1
s_branch DB_72
PD_73:
ds_write_b32 v1, v1 offset:364
s_branch L_cg2
L_cg1:
W_74:
ds_read_b32 v16, v1 offset:364
s_waitcnt lgkmcnt(0)
v_cmp_le_u32 vcc, 1, v16
s_cbranch_vccnz D_75
s_add_u32 s34, s34, 1
s_cmp_lt_u32 s34, 2097152
s_cbranch_scc0 L_done
s_sleep 1
s_branch W_74
D_75:
L_cg2:
PS_78:
buffer_load_dwordx4 v[16:19], v9, s[36:39], s54 offen sc1
s_waitcnt vmcnt(0)
v_xor_b32 v17, s68, v17
v_xor_b32 v19, s68, v19
v_or_b32 v17, v17, v19
v_cmp_ne_u32 vcc, 0, v17
s_cbranch_vccz PD_79
s_add_u32 s34, s34, 1
s_cmp_lt_u32 s34, 2097152
s_cbranch_scc0 L_done
s_sleep 1
s_branch PS_78
PD_79:
s_mov_b32 s57, s55
buffer_load_dwordx4 v[64:67], v11, s[36:39], s57 offen sc1
s_add_u32 s57, s57, 32768
buffer_load_dwordx4 v[68:71], v11, s[36:39], s57 offen sc1
s_add_u32 s57, s57, 32768
buffer_load_dwordx4 v[72:75], v11, s[36:39], s57 offen sc1
s_add_u32 s57, s57, 32768
buffer_load_dwordx4 v[76:79], v11, s[36:39], s57 offen sc1
s_add_u32 s57, s57, 32768
buffer_load_dwordx4 v[80:83], v11, s[36:39], s57 offen sc1
s_add_u32 s57, s57, 32768
buffer_load_dwordx4 v[84:87], v11, s[36:39], s57 offen sc1
s_add_u32 s57, s57, 32768
buffer_load_dwordx4 v[88:91], v11, s[36:39], s57 offen sc1
s_add_u32 s57, s57, 32768
buffer_load_dwordx4 v[92:95], v11, s[36:39], s57 offen sc1
ds_write_b32 v6, v6 offset:288
v_mov_b32 v32, v16
s_nop 1
v_max_f32_dpp v32, v32, v32 quad_perm:[1,0,3,2] row_mask:0xf bank_mask:0xf
s_nop 1
v_max_f32_dpp v32, v32, v32 quad_perm:[2,3,0,1] row_mask:0xf bank_mask:0xf
s_nop 1
v_max_f32_dpp v32, v32, v32 row_ror:4 row_mask:0xf bank_mask:0xf
v_mov_b32 v33, v32
s_nop 1
v_permlane16_swap_b32 v32, v33
v_max_f32 v32, v32, v33
v_mov_b32 v33, v32
s_nop 1
v_permlane32_swap_b32 v32, v33
v_max_f32 v32, v32, v33
v_sub_f32 v16, v16, v32
v_exp_f32 v16, v16
s_nop 0
v_mul_f32 v33, v16, v18
s_nop 1
v_add_f32_dpp v33, v33, v33 quad_perm:[1,0,3,2] row_mask:0xf bank_mask:0xf
s_nop 1
v_add_f32_dpp v33, v33, v33 quad_perm:[2,3,0,1] row_mask:0xf bank_mask:0xf
s_nop 1
v_add_f32_dpp v33, v33, v33 row_ror:4 row_mask:0xf bank_mask:0xf
v_mov_b32 v34, v33
s_nop 1
v_permlane16_swap_b32 v33, v34
v_add_f32 v33, v33, v34
v_mov_b32 v34, v33
s_nop 1
v_permlane32_swap_b32 v33, v34
v_add_f32 v33, v33, v34
v_rcp_f32 v33, v33
s_nop 0
v_mul_f32 v16, v16, v33
v_cvt_pk_bf16_f32 v16, v16, v16
s_nop 1
v_and_b32_dpp v96, v16, v36 row_newbcast:0 row_mask:0xf bank_mask:0xf
v_and_b32_dpp v97, v16, v37 row_newbcast:0 row_mask:0xf bank_mask:0xf
v_and_b32_dpp v98, v16, v38 row_newbcast:0 row_mask:0xf bank_mask:0xf
v_and_b32_dpp v99, v16, v39 row_newbcast:0 row_mask:0xf bank_mask:0xf
v_and_b32_dpp v100, v16, v36 row_newbcast:1 row_mask:0xf bank_mask:0xf
v_and_b32_dpp v101, v16, v37 row_newbcast:1 row_mask:0xf bank_mask:0xf
v_and_b32_dpp v102, v16, v38 row_newbcast:1 row_mask:0xf bank_mask:0xf
v_and_b32_dpp v103, v16, v39 row_newbcast:1 row_mask:0xf bank_mask:0xf
v_and_b32_dpp v104, v16, v36 row_newbcast:2 row_mask:0xf bank_mask:0xf
v_and_b32_dpp v105, v16, v37 row_newbcast:2 row_mask:0xf bank_mask:0xf
v_and_b32_dpp v106, v16, v38 row_newbcast:2 row_mask:0xf bank_mask:0xf
v_and_b32_dpp v107, v16, v39 row_newbcast:2 row_mask:0xf bank_mask:0xf
v_and_b32_dpp v108, v16, v36 row_newbcast:3 row_mask:0xf bank_mask:0xf
v_and_b32_dpp v109, v16, v37 row_newbcast:3 row_mask:0xf bank_mask:0xf
v_and_b32_dpp v110, v16, v38 row_newbcast:3 row_mask:0xf bank_mask:0xf
v_and_b32_dpp v111, v16, v39 row_newbcast:3 row_mask:0xf bank_mask:0xf
v_and_b32_dpp v112, v16, v36 row_newbcast:4 row_mask:0xf bank_mask:0xf
v_and_b32_dpp v113, v16, v37 row_newbcast:4 row_mask:0xf bank_mask:0xf
v_and_b32_dpp v114, v16, v38 row_newbcast:4 row_mask:0xf bank_mask:0xf
v_and_b32_dpp v115, v16, v39 row_newbcast:4 row_mask:0xf bank_mask:0xf
v_and_b32_dpp v116, v16, v36 row_newbcast:5 row_mask:0xf bank_mask:0xf
v_and_b32_dpp v117, v16, v37 row_newbcast:5 row_mask:0xf bank_mask:0xf
v_and_b32_dpp v118, v16, v38 row_newbcast:5 row_mask:0xf bank_mask:0xf
v_and_b32_dpp v119, v16, v39 row_newbcast:5 row_mask:0xf bank_mask:0xf
v_and_b32_dpp v120, v16, v36 row_newbcast:6 row_mask:0xf bank_mask:0xf
v_and_b32_dpp v121, v16, v37 row_newbcast:6 row_mask:0xf bank_mask:0xf
v_and_b32_dpp v122, v16, v38 row_newbcast:6 row_mask:0xf bank_mask:0xf
v_and_b32_dpp v123, v16, v39 row_newbcast:6 row_mask:0xf bank_mask:0xf
v_and_b32_dpp v124, v16, v36 row_newbcast:7 row_mask:0xf bank_mask:0xf
v_and_b32_dpp v125, v16, v37 row_newbcast:7 row_mask:0xf bank_mask:0xf
v_and_b32_dpp v126, v16, v38 row_newbcast:7 row_mask:0xf bank_mask:0xf
v_and_b32_dpp v127, v16, v39 row_newbcast:7 row_mask:0xf bank_mask:0xf
s_branch PC_82
PO_80:
s_mov_b32 s57, s55
buffer_load_dwordx4 v[64:67], v11, s[36:39], s57 offen sc1
s_add_u32 s57, s57, 32768
buffer_load_dwordx4 v[68:71], v11, s[36:39], s57 offen sc1
s_add_u32 s57, s57, 32768
buffer_load_dwordx4 v[72:75], v11, s[36:39], s57 offen sc1
s_add_u32 s57, s57, 32768
buffer_load_dwordx4 v[76:79], v11, s[36:39], s57 offen sc1
s_add_u32 s57, s57, 32768
buffer_load_dwordx4 v[80:83], v11, s[36:39], s57 offen sc1
s_add_u32 s57, s57, 32768
buffer_load_dwordx4 v[84:87], v11, s[36:39], s57 offen sc1
s_add_u32 s57, s57, 32768
buffer_load_dwordx4 v[88:91], v11, s[36:39], s57 offen sc1
s_add_u32 s57, s57, 32768
buffer_load_dwordx4 v[92:95], v11, s[36:39], s57 offen sc1
PC_82:
s_waitcnt vmcnt(7)
v_mfma_f32_16x16x32_bf16 v[40:43], v[96:99], v[64:67], 0
v_max3_u32 v35, v64, v65, v66
v_max_u32 v35, v35, v67
s_waitcnt vmcnt(6)
v_mfma_f32_16x16x32_bf16 v[40:43], v[100:103], v[68:71], v[40:43]
v_max3_u32 v35, v35, v68, v69
v_max3_u32 v35, v35, v70, v71
s_waitcnt vmcnt(5)
v_mfma_f32_16x16x32_bf16 v[40:43], v[104:107], v[72:75], v[40:43]
v_max3_u32 v35, v35, v72, v73
v_max3_u32 v35, v35, v74, v75
s_waitcnt vmcnt(4)
v_mfma_f32_16x16x32_bf16 v[40:43], v[108:111], v[76:79], v[40:43]
v_max3_u32 v35, v35, v76, v77
v_max3_u32 v35, v35, v78, v79
s_waitcnt vmcnt(3)
v_mfma_f32_16x16x32_bf16 v[40:43], v[112:115], v[80:83], v[40:43]
v_max3_u32 v35, v35, v80, v81
v_max3_u32 v35, v35, v82, v83
s_waitcnt vmcnt(2)
v_mfma_f32_16x16x32_bf16 v[40:43], v[116:119], v[84:87], v[40:43]
v_max3_u32 v35, v35, v84, v85
v_max3_u32 v35, v35, v86, v87
s_waitcnt vmcnt(1)
v_mfma_f32_16x16x32_bf16 v[40:43], v[120:123], v[88:91], v[40:43]
v_max3_u32 v35, v35, v88, v89
v_max3_u32 v35, v35, v90, v91
s_waitcnt vmcnt(0)
v_mfma_f32_16x16x32_bf16 v[40:43], v[124:127], v[92:95], v[40:43]
v_max3_u32 v35, v35, v92, v93
v_max3_u32 v35, v35, v94, v95
v_cmp_eq_u32 vcc, -1, v35
s_cbranch_vccz PD_81
s_add_u32 s34, s34, 1
s_cmp_lt_u32 s34, 2097152
s_cbranch_scc0 L_done
s_branch PO_80
PD_81:
s_nop 4
s_mov_b32 exec_hi, 0
v_cvt_pk_bf16_f32 v44, v40, v41
v_cvt_pk_bf16_f32 v45, v42, v43
ds_write_b64 v12, v[44:45]
s_mov_b64 exec, -1
ds_write_b32 v6, v6 offset:224
W_83:
ds_read_b128 v[32:35], v1 offset:224
ds_read_b128 v[48:51], v13 offset:2560
ds_read_b128 v[52:55], v13 offset:2624
ds_read_b128 v[56:59], v13 offset:2688
ds_read_b128 v[60:63], v13 offset:2752
s_waitcnt lgkmcnt(0)
v_min_u32 v32, v32, v33
v_min3_u32 v32, v32, v34, v35
v_cmp_le_u32 vcc, 1, v32
s_cbranch_vccnz D_84
s_add_u32 s34, s34, 1
s_cmp_lt_u32 s34, 2097152
s_cbranch_scc0 L_done
s_branch W_83
D_84:
v_mfma_f32_16x16x32_bf16 v[16:19], v[224:227], v[48:51], 0
v_mfma_f32_16x16x32_bf16 v[20:23], v[240:243], v[48:51], 0
v_mfma_f32_16x16x32_bf16 v[16:19], v[228:231], v[52:55], v[16:19]
v_mfma_f32_16x16x32_bf16 v[20:23], v[244:247], v[52:55], v[20:23]
v_mfma_f32_16x16x32_bf16 v[16:19], v[232:235], v[56:59], v[16:19]
v_mfma_f32_16x16x32_bf16 v[20:23], v[248:251], v[56:59], v[20:23]
v_mfma_f32_16x16x32_bf16 v[16:19], v[236:239], v[60:63], v[16:19]
v_mfma_f32_16x16x32_bf16 v[20:23], v[252:255], v[60:63], v[20:23]
s_mov_b64 exec, s[60:61]
s_nop 5
v_cvt_pk_bf16_f32 v24, v16, v17
v_cvt_pk_bf16_f32 v25, v18, v19
v_cvt_pk_bf16_f32 v26, v20, v21
v_cvt_pk_bf16_f32 v27, v22, v23
v_min_u32 v24, -2, v24
v_min_u32 v25, -2, v25
v_min_u32 v26, -2, v26
v_min_u32 v27, -2, v27
s_cmp_eq_u32 s35, 1
s_cbranch_scc1 SL_85
buffer_store_dwordx4 v[24:27], v15, s[36:39], s56 offen sc1
s_branch SE_86
SL_85:
buffer_store_dwordx4 v[24:27], v15, s[36:39], s56 offen
SE_86:
s_mov_b64 exec, -1
s_endpgm
L_p5:
s_lshl_b32 s56, s3, 2
s_add_u32 s56, s56, s30
s_lshl_b32 s56, s56, 12
s_add_u32 s56, s56, 262144
v_bfe_u32 v8, v0, 3, 2
v_lshlrev_b32 v8, 5, v8
v_lshrrev_b32 v9, 2, v0
v_lshl_add_u32 v8, v9, 7, v8
v_lshl_add_u32 v8, v2, 3, v8
s_lshl_b32 s6, s30, 14
s_add_u32 s6, s6, 32768
v_add_u32 v8, s6, v8
W_87:
ds_read_b32 v15, v1 offset:356
s_waitcnt lgkmcnt(0)
v_cmp_le_u32 vcc, 2, v15
s_cbranch_vccnz D_88
s_add_u32 s34, s34, 1
s_cmp_lt_u32 s34, 2097152
s_cbranch_scc0 L_done
s_sleep 4
s_branch W_87
D_88:
v_xor_b32 v9, 0, v8
ds_read_b64_tr_b16 v[96:97], v9 offset:0
ds_read_b64_tr_b16 v[98:99], v9 offset:2048
ds_read_b64_tr_b16 v[100:101], v9 offset:4096
ds_read_b64_tr_b16 v[102:103], v9 offset:6144
ds_read_b64_tr_b16 v[104:105], v9 offset:8192
ds_read_b64_tr_b16 v[106:107], v9 offset:10240
ds_read_b64_tr_b16 v[108:109], v9 offset:12288
ds_read_b64_tr_b16 v[110:111], v9 offset:14336
s_waitcnt lgkmcnt(4)
v_xor_b32 v9, 32, v8
ds_read_b64_tr_b16 v[112:113], v9 offset:0
ds_read_b64_tr_b16 v[114:115], v9 offset:2048
ds_read_b64_tr_b16 v[116:117], v9 offset:4096
ds_read_b64_tr_b16 v[118:119], v9 offset:6144
ds_read_b64_tr_b16 v[120:121], v9 offset:8192
ds_read_b64_tr_b16 v[122:123], v9 offset:10240
ds_read_b64_tr_b16 v[124:125], v9 offset:12288
ds_read_b64_tr_b16 v[126:127], v9 offset:14336
s_waitcnt lgkmcnt(4)
v_xor_b32 v9, 64, v8
ds_read_b64_tr_b16 v[128:129], v9 offset:0
ds_read_b64_tr_b16 v[130:131], v9 offset:2048
ds_read_b64_tr_b16 v[132:133], v9 offset:4096
ds_read_b64_tr_b16 v[134:135], v9 offset:6144
ds_read_b64_tr_b16 v[136:137], v9 offset:8192
ds_read_b64_tr_b16 v[138:139], v9 offset:10240
ds_read_b64_tr_b16 v[140:141], v9 offset:12288
ds_read_b64_tr_b16 v[142:143], v9 offset:14336
s_waitcnt lgkmcnt(4)
v_xor_b32 v9, 96, v8
ds_read_b64_tr_b16 v[144:145], v9 offset:0
ds_read_b64_tr_b16 v[146:147], v9 offset:2048
ds_read_b64_tr_b16 v[148:149], v9 offset:4096
ds_read_b64_tr_b16 v[150:151], v9 offset:6144
ds_read_b64_tr_b16 v[152:153], v9 offset:8192
ds_read_b64_tr_b16 v[154:155], v9 offset:10240
ds_read_b64_tr_b16 v[156:157], v9 offset:12288
ds_read_b64_tr_b16 v[158:159], v9 offset:14336
v_lshlrev_b32 v10, 7, v4
v_lshl_add_u32 v10, v5, 4, v10
s_lshl_b32 s6, s30, 11
s_add_u32 s6, s6, 131072
v_add_u32 v10, s6, v10
s_mov_b32 s70, 0x00ff00ff
s_mov_b32 s71, 0x00ff00ff
v_lshlrev_b32 v11, 10, v4
v_lshl_add_u32 v11, v5, 3, v11
v_lshlrev_b32 v12, 7, v5
v_lshl_add_u32 v12, v4, 4, v12
v_add_u32 v12, 131072, v12
s_lshl_b32 s59, s3, 12
s_and_b32 s6, s4, 7
s_lshl_b32 s6, s6, 7
s_add_u32 s59, s59, s6
s_add_u32 s59, s59, 1835008
s_lshl_b32 s58, s3, 11
s_and_b32 s7, s4, 7
s_lshl_b32 s7, s7, 7
s_add_u32 s58, s58, s7
s_add_u32 s58, s58, 704512
W_89:
ds_read_b32 v15, v1 offset:352
s_waitcnt lgkmcnt(0)
v_cmp_le_u32 vcc, 1, v15
s_cbranch_vccnz D_90
s_add_u32 s34, s34, 1
s_cmp_lt_u32 s34, 2097152
s_cbranch_scc0 L_done
s_sleep 4
s_branch W_89
D_90:
v_readfirstlane_b32 s35, v15
s_nop 0
s_sub_u32 s35, s35, 1
W_91:
ds_read_b128 v[32:35], v1 offset:288
s_waitcnt lgkmcnt(0)
v_min_u32 v32, v32, v33
v_min3_u32 v32, v32, v34, v35
v_cmp_le_u32 vcc, 1, v32
s_cbranch_vccnz D_92
s_add_u32 s34, s34, 1
s_cmp_lt_u32 s34, 2097152
s_cbranch_scc0 L_done
s_sleep 2
s_branch W_91
D_92:
buffer_load_dwordx4 v[16:19], v7, s[36:39], s56 offen offset:0 sc1
buffer_load_dwordx4 v[20:23], v7, s[36:39], s56 offen offset:1024 sc1
buffer_load_dwordx4 v[24:27], v7, s[36:39], s56 offen offset:2048 sc1
buffer_load_dwordx4 v[28:31], v7, s[36:39], s56 offen offset:3072 sc1
W_93:
ds_read_b128 v[32:35], v1 offset:224
s_waitcnt lgkmcnt(0)
v_min_u32 v32, v32, v33
v_min3_u32 v32, v32, v34, v35
v_cmp_le_u32 vcc, 1, v32
s_cbranch_vccnz D_94
s_add_u32 s34, s34, 1
s_cmp_lt_u32 s34, 2097152
s_cbranch_scc0 L_done
s_sleep 1
s_branch W_93
D_94:
P_95:
buffer_load_dwordx4 v[16:19], v7, s[36:39], s56 offen offset:0 sc1
buffer_load_dwordx4 v[20:23], v7, s[36:39], s56 offen offset:1024 sc1
buffer_load_dwordx4 v[24:27], v7, s[36:39], s56 offen offset:2048 sc1
buffer_load_dwordx4 v[28:31], v7, s[36:39], s56 offen offset:3072 sc1
s_waitcnt vmcnt(3)
v_mfma_f32_16x16x32_bf16 v[32:35], v[96:99], v[16:19], 0
v_mfma_f32_16x16x32_bf16 v[36:39], v[112:115], v[16:19], 0
v_mfma_f32_16x16x32_bf16 v[40:43], v[128:131], v[16:19], 0
v_mfma_f32_16x16x32_bf16 v[44:47], v[144:147], v[16:19], 0
v_max3_u32 v15, v16, v17, v18
v_max_u32 v15, v15, v19
s_waitcnt vmcnt(2)
v_mfma_f32_16x16x32_bf16 v[32:35], v[100:103], v[20:23], v[32:35]
v_mfma_f32_16x16x32_bf16 v[36:39], v[116:119], v[20:23], v[36:39]
v_mfma_f32_16x16x32_bf16 v[40:43], v[132:135], v[20:23], v[40:43]
v_mfma_f32_16x16x32_bf16 v[44:47], v[148:151], v[20:23], v[44:47]
v_max3_u32 v15, v15, v20, v21
v_max3_u32 v15, v15, v22, v23
s_waitcnt vmcnt(1)
v_mfma_f32_16x16x32_bf16 v[32:35], v[104:107], v[24:27], v[32:35]
v_mfma_f32_16x16x32_bf16 v[36:39], v[120:123], v[24:27], v[36:39]
v_mfma_f32_16x16x32_bf16 v[40:43], v[136:139], v[24:27], v[40:43]
v_mfma_f32_16x16x32_bf16 v[44:47], v[152:155], v[24:27], v[44:47]
v_max3_u32 v15, v15, v24, v25
v_max3_u32 v15, v15, v26, v27
s_waitcnt vmcnt(0)
v_mfma_f32_16x16x32_bf16 v[32:35], v[108:111], v[28:31], v[32:35]
v_mfma_f32_16x16x32_bf16 v[36:39], v[124:127], v[28:31], v[36:39]
v_mfma_f32_16x16x32_bf16 v[40:43], v[140:143], v[28:31], v[40:43]
v_mfma_f32_16x16x32_bf16 v[44:47], v[156:159], v[28:31], v[44:47]
v_max3_u32 v15, v15, v28, v29
v_max3_u32 v15, v15, v30, v31
v_cmp_eq_u32 vcc, -1, v15
s_cbranch_vccz PD_96
s_add_u32 s34, s34, 1
s_cmp_lt_u32 s34, 2097152
s_cbranch_scc0 L_done
s_branch P_95
PD_96:
s_nop 3
v_add_f32_dpp v32, v32, v32 row_ror:8 row_mask:0xf bank_mask:0xf
v_add_f32_dpp v33, v33, v33 row_ror:8 row_mask:0xf bank_mask:0xf
v_add_f32_dpp v34, v34, v34 row_ror:8 row_mask:0xf bank_mask:0xf
v_add_f32_dpp v35, v35, v35 row_ror:8 row_mask:0xf bank_mask:0xf
v_add_f32_dpp v36, v36, v36 row_ror:8 row_mask:0xf bank_mask:0xf
v_add_f32_dpp v37, v37, v37 row_ror:8 row_mask:0xf bank_mask:0xf
v_add_f32_dpp v38, v38, v38 row_ror:8 row_mask:0xf bank_mask:0xf
v_add_f32_dpp v39, v39, v39 row_ror:8 row_mask:0xf bank_mask:0xf
v_add_f32_dpp v40, v40, v40 row_ror:8 row_mask:0xf bank_mask:0xf
v_add_f32_dpp v41, v41, v41 row_ror:8 row_mask:0xf bank_mask:0xf
v_add_f32_dpp v42, v42, v42 row_ror:8 row_mask:0xf bank_mask:0xf
v_add_f32_dpp v43, v43, v43 row_ror:8 row_mask:0xf bank_mask:0xf
v_add_f32_dpp v44, v44, v44 row_ror:8 row_mask:0xf bank_mask:0xf
v_add_f32_dpp v45, v45, v45 row_ror:8 row_mask:0xf bank_mask:0xf
v_add_f32_dpp v46, v46, v46 row_ror:8 row_mask:0xf bank_mask:0xf
v_add_f32_dpp v47, v47, v47 row_ror:8 row_mask:0xf bank_mask:0xf
s_mov_b64 exec, s[70:71]
ds_write_b128 v10, v[32:35] offset:0
ds_write_b128 v10, v[36:39] offset:512
ds_write_b128 v10, v[40:43] offset:1024
ds_write_b128 v10, v[44:47] offset:1536
s_mov_b64 exec, -1
ds_write_b32 v6, v6 offset:256
s_cmp_lg_u32 s30, 0
s_cbranch_scc1 L_rend5
W_97:
ds_read_b128 v[56:59], v1 offset:272
ds_read_b128 v[64:67], v12 offset:0
ds_read_b128 v[68:71], v12 offset:64
ds_read_b128 v[72:75], v12 offset:2048
ds_read_b128 v[76:79], v12 offset:2112
ds_read_b128 v[80:83], v12 offset:4096
ds_read_b128 v[84:87], v12 offset:4160
ds_read_b128 v[88:91], v12 offset:6144
ds_read_b128 v[92:95], v12 offset:6208
s_waitcnt lgkmcnt(0)
v_min_u32 v56, v56, v57
v_min3_u32 v56, v56, v58, v59
v_cmp_le_u32 vcc, 1, v56
s_cbranch_vccnz D_98
s_add_u32 s34, s34, 1
s_cmp_lt_u32 s34, 2097152
s_cbranch_scc0 L_done
s_branch W_97
D_98:
v_pk_add_f32 v[64:65], v[64:65], v[72:73]
v_pk_add_f32 v[80:81], v[80:81], v[88:89]
v_pk_add_f32 v[66:67], v[66:67], v[74:75]
v_pk_add_f32 v[82:83], v[82:83], v[90:91]
v_pk_add_f32 v[68:69], v[68:69], v[76:77]
v_pk_add_f32 v[84:85], v[84:85], v[92:93]
v_pk_add_f32 v[70:71], v[70:71], v[78:79]
v_pk_add_f32 v[86:87], v[86:87], v[94:95]
v_pk_add_f32 v[64:65], v[64:65], v[80:81]
v_pk_add_f32 v[66:67], v[66:67], v[82:83]
v_pk_add_f32 v[68:69], v[68:69], v[84:85]
v_pk_add_f32 v[70:71], v[70:71], v[86:87]
v_pk_add_f32 v[64:65], v[64:65], v[68:69]
v_pk_add_f32 v[66:67], v[66:67], v[70:71]
v_cvt_pk_bf16_f32 v16, v64, v65
v_cvt_pk_bf16_f32 v17, v66, v67
v_min_u32 v16, -2, v16
v_min_u32 v17, -2, v17
buffer_store_dwordx2 v[16:17], v11, s[36:39], s59 offen sc1
v_mov_b32 v18, 0
v_mov_b32 v19, s68
s_mov_b64 exec, 1
s_cmp_eq_u32 s35, 1
s_cbranch_scc1 SL_99
buffer_store_dword v19, v18, s[36:39], s58 offen sc1
s_branch SE_100
SL_99:
buffer_store_dword v19, v18, s[36:39], s58 offen
SE_100:
buffer_store_dword v19, v18, s[36:39], s58 offen offset:1024 sc1
s_mov_b64 exec, -1
L_rend5:
s_endpgm
L_mlp:
s_cmp_lt_u32 s5, 4
s_cbranch_scc1 L_mlp2
s_add_u32 m0, s21, 3072
s_add_u32 s6, s59, 114688
buffer_load_dwordx4 v63, s[40:43], s6 offen  lds
s_add_u32 m0, s21, 4096
s_add_u32 s6, s59, 229376
buffer_load_dwordx4 v62, s[40:43], s6 offen  lds
s_add_u32 m0, s21, 5120
s_add_u32 s6, s59, 229376
buffer_load_dwordx4 v63, s[40:43], s6 offen  lds
s_add_u32 m0, s21, 6144
s_add_u32 s6, s59, 344064
buffer_load_dwordx4 v62, s[40:43], s6 offen  lds
s_add_u32 m0, s21, 7168
s_add_u32 s6, s59, 344064
buffer_load_dwordx4 v63, s[40:43], s6 offen  lds
s_mov_b32 s48, s26
s_and_b32 s49, s27, 0xffff
s_mov_b32 s50, 1835008
s_mov_b32 s51, 0x20000
s_and_b32 s57, s5, 3
s_lshl_b32 s7, s57, 13
s_add_u32 m0, s7, 98304
s_lshl_b32 s56, s3, 3
s_and_b32 s6, s4, 7
s_add_u32 s56, s56, s6
s_lshl_b32 s56, s56, 15
s_and_b32 s6, s57, 1
s_lshl_b32 s6, s6, 14
s_add_u32 s56, s56, s6
s_lshr_b32 s6, s57, 1
s_lshl_b32 s6, s6, 12
s_add_u32 s56, s56, s6
v_xor_b32 v15, 0, v7
buffer_load_dwordx4 v15, s[48:51], s56 offen nt lds
s_add_u32 m0, m0, 1024
s_add_u32 s56, s56, 1024
v_xor_b32 v15, 32, v7
buffer_load_dwordx4 v15, s[48:51], s56 offen nt lds
s_add_u32 m0, m0, 1024
s_add_u32 s56, s56, 1024
v_xor_b32 v15, 64, v7
buffer_load_dwordx4 v15, s[48:51], s56 offen nt lds
s_add_u32 m0, m0, 1024
s_add_u32 s56, s56, 1024
v_xor_b32 v15, 96, v7
buffer_load_dwordx4 v15, s[48:51], s56 offen nt lds
s_add_u32 m0, m0, 1024
s_add_u32 s56, s56, 5120
v_xor_b32 v15, 128, v7
buffer_load_dwordx4 v15, s[48:51], s56 offen nt lds
s_add_u32 m0, m0, 1024
s_add_u32 s56, s56, 1024
v_xor_b32 v15, 160, v7
buffer_load_dwordx4 v15, s[48:51], s56 offen nt lds
s_add_u32 m0, m0, 1024
s_add_u32 s56, s56, 1024
v_xor_b32 v15, 192, v7
buffer_load_dwordx4 v15, s[48:51], s56 offen nt lds
s_add_u32 m0, m0, 1024
s_add_u32 s56, s56, 1024
v_xor_b32 v15, 224, v7
buffer_load_dwordx4 v15, s[48:51], s56 offen nt lds
s_add_u32 m0, m0, 1024
s_add_u32 s56, s56, 1024
s_xor_b32 s21, s21, 0x8000
s_add_u32 m0, s21, 0
s_add_u32 s6, s59, 0
buffer_load_dwordx4 v62, s[44:47], s6 offen  lds
s_add_u32 m0, s21, 1024
s_add_u32 s6, s59, 0
buffer_load_dwordx4 v63, s[44:47], s6 offen  lds
s_add_u32 m0, s21, 2048
s_add_u32 s6, s59, 114688
buffer_load_dwordx4 v62, s[44:47], s6 offen  lds
s_add_u32 m0, s21, 3072
s_add_u32 s6, s59, 114688
buffer_load_dwordx4 v63, s[44:47], s6 offen  lds
s_add_u32 m0, s21, 4096
s_add_u32 s6, s59, 229376
buffer_load_dwordx4 v62, s[44:47], s6 offen  lds
s_add_u32 m0, s21, 5120
s_add_u32 s6, s59, 229376
buffer_load_dwordx4 v63, s[44:47], s6 offen  lds
s_add_u32 m0, s21, 6144
s_add_u32 s6, s59, 344064
buffer_load_dwordx4 v62, s[44:47], s6 offen  lds
s_add_u32 m0, s21, 7168
s_add_u32 s6, s59, 344064
buffer_load_dwordx4 v63, s[44:47], s6 offen  lds
s_waitcnt vmcnt(0)
ds_write_b32 v6, v6 offset:320
s_waitcnt lgkmcnt(0)
s_endpgm
L_mlp2:
v_lshrrev_b32 v8, 5, v0
v_lshlrev_b32 v8, 8, v8
v_lshl_add_u32 v8, v5, 4, v8
v_and_b32 v9, 1, v4
v_lshl_add_u32 v8, v9, 3, v8
s_mul_i32 s6, s5, 1040
s_add_u32 s6, s6, 147456
v_add_u32 v14, s6, v8
ds_read_b64 v[60:61], v14
ds_read_b64 v[62:63], v14 offset:512
s_mul_i32 s6, s5, 1056
s_add_u32 s6, s6, 139264
v_add_u32 v8, s6, v8
v_lshlrev_b32 v9, 12, v4
v_lshl_add_u32 v9, v5, 4, v9
s_lshl_b32 s54, s5, 10
s_add_u32 s54, s54, 1835008
s_add_u32 s55, s54, 16384
s_and_b32 s6, s5, 1
v_and_b32 v10, 1, v4
v_xor_b32 v10, s6, v10
v_lshlrev_b32 v10, 5, v10
v_lshrrev_b32 v11, 2, v0
v_lshl_add_u32 v10, v11, 6, v10
v_lshl_add_u32 v10, v2, 3, v10
s_cmp_lt_u32 s5, 2
s_cselect_b32 s6, 0, 0x8000
v_add_u32 v10, s6, v10
s_cselect_b32 s58, 0, 0xff800000
v_and_b32 v12, 7, v11
v_lshlrev_b32 v12, 5, v12
v_lshl_add_u32 v12, v11, 10, v12
v_lshl_add_u32 v12, v2, 3, v12
s_lshl_b32 s6, s5, 8
s_add_u32 s6, s6, 98304
v_add_u32 v12, s6, v12
v_mul_u32_u24 v13, 1056, v2
v_lshl_add_u32 v13, v4, 4, v13
v_add_u32 v13, 139264, v13
v_lshlrev_b32 v56, 6, v2
v_lshl_add_u32 v56, v4, 4, v56
v_add_u32 v56, v56, v1
s_lshl_b32 s6, s5, 8
v_add_u32 v56, s6, v56
v_lshrrev_b32 v57, 5, v0
v_lshlrev_b32 v57, 8, v57
v_lshl_add_u32 v57, v2, 6, v57
v_and_b32 v58, 1, v4
v_lshl_add_u32 v57, v58, 5, v57
v_add_u32 v57, v57, v1
s_lshl_b32 s56, s3, 3
s_and_b32 s6, s4, 7
s_add_u32 s56, s56, s6
s_lshr_b32 s7, s56, 5
s_lshl_b32 s7, s7, 19
s_and_b32 s56, s56, 31
s_lshl_b32 s56, s56, 12
s_add_u32 s56, s56, s7
s_lshl_b32 s6, s5, 10
s_add_u32 s56, s56, s6
s_add_u32 s56, s56, 786432
v_and_b32 v14, 1, v5
v_lshlrev_b32 v14, 4, v14
v_mov_b32 v15, 0x3f80
v_lshlrev_b32 v14, v14, v15
v_lshrrev_b32 v15, 1, v5
v_cmp_eq_u32 vcc, 0, v15
s_nop 1
v_cndmask_b32 v48, 0, v14, vcc
v_cmp_eq_u32 vcc, 1, v15
s_nop 1
v_cndmask_b32 v49, 0, v14, vcc
v_cmp_eq_u32 vcc, 2, v15
s_nop 1
v_cndmask_b32 v50, 0, v14, vcc
v_cmp_eq_u32 vcc, 3, v15
s_nop 1
v_cndmask_b32 v51, 0, v14, vcc
v_cmp_eq_u32 vcc, 4, v15
s_nop 1
v_cndmask_b32 v52, 0, v14, vcc
v_cmp_eq_u32 vcc, 5, v15
s_nop 1
v_cndmask_b32 v53, 0, v14, vcc
v_cmp_eq_u32 vcc, 6, v15
s_nop 1
v_cndmask_b32 v54, 0, v14, vcc
v_cmp_eq_u32 vcc, 7, v15
s_nop 1
v_cndmask_b32 v55, 0, v14, vcc
s_lshl_b32 s59, s3, 11
s_and_b32 s7, s4, 7
s_lshl_b32 s7, s7, 7
s_add_u32 s59, s59, s7
s_add_u32 s59, s59, 1228800
W_101:
ds_read_b32 v14, v1 offset:352
s_waitcnt lgkmcnt(0)
v_cmp_le_u32 vcc, 1, v14
s_cbranch_vccnz D_102
s_add_u32 s34, s34, 1
s_cmp_lt_u32 s34, 2097152
s_cbranch_scc0 L_done
s_sleep 4
s_branch W_101
D_102:
v_readfirstlane_b32 s35, v14
s_nop 0
s_sub_u32 s35, s35, 1
s_waitcnt lgkmcnt(0)
v_lshlrev_b32 v224, 16, v60
v_and_b32 v225, 0xffff0000, v60
v_lshlrev_b32 v226, 16, v61
v_and_b32 v227, 0xffff0000, v61
v_lshlrev_b32 v228, 16, v62
v_and_b32 v229, 0xffff0000, v62
v_lshlrev_b32 v230, 16, v63
v_and_b32 v231, 0xffff0000, v63
s_mov_b32 s57, 0
s_lshl_b32 s52, s3, 11
s_add_u32 s52, s52, 704512
s_cmp_eq_u32 s35, 1
s_cselect_b32 s6, 0, 1024
s_cselect_b32 s7, 7, 7
s_add_u32 s52, s52, s6
v_and_b32 v16, 7, v0
v_lshlrev_b32 v16, s7, v16
MB_103:
buffer_load_dword v17, v16, s[36:39], s52 offen sc1
s_cmp_lg_u32 s57, 0
s_cbranch_scc1 MN_105
ds_read_b128 v[20:23], v1 offset:336
s_waitcnt lgkmcnt(0)
v_min_u32 v20, v20, v21
v_min3_u32 v20, v20, v22, v23
v_cmp_le_u32 vcc, 1, v20
s_cbranch_vccz MN_105
s_mov_b32 s57, 1
ds_read_b64_tr_b16 v[128:129], v10 offset:0
ds_read_b64_tr_b16 v[130:131], v10 offset:1024
ds_read_b64_tr_b16 v[132:133], v10 offset:2048
ds_read_b64_tr_b16 v[134:135], v10 offset:3072
ds_read_b64_tr_b16 v[136:137], v10 offset:4096
ds_read_b64_tr_b16 v[138:139], v10 offset:5120
ds_read_b64_tr_b16 v[140:141], v10 offset:6144
ds_read_b64_tr_b16 v[142:143], v10 offset:7168
s_waitcnt lgkmcnt(4)
ds_read_b64_tr_b16 v[144:145], v10 offset:8192
ds_read_b64_tr_b16 v[146:147], v10 offset:9216
ds_read_b64_tr_b16 v[148:149], v10 offset:10240
ds_read_b64_tr_b16 v[150:151], v10 offset:11264
ds_read_b64_tr_b16 v[152:153], v10 offset:12288
ds_read_b64_tr_b16 v[154:155], v10 offset:13312
ds_read_b64_tr_b16 v[156:157], v10 offset:14336
ds_read_b64_tr_b16 v[158:159], v10 offset:15360
s_waitcnt lgkmcnt(4)
ds_read_b64_tr_b16 v[160:161], v10 offset:16384
ds_read_b64_tr_b16 v[162:163], v10 offset:17408
ds_read_b64_tr_b16 v[164:165], v10 offset:18432
ds_read_b64_tr_b16 v[166:167], v10 offset:19456
ds_read_b64_tr_b16 v[168:169], v10 offset:20480
ds_read_b64_tr_b16 v[170:171], v10 offset:21504
ds_read_b64_tr_b16 v[172:173], v10 offset:22528
ds_read_b64_tr_b16 v[174:175], v10 offset:23552
s_waitcnt lgkmcnt(4)
ds_read_b64_tr_b16 v[176:177], v10 offset:24576
ds_read_b64_tr_b16 v[178:179], v10 offset:25600
ds_read_b64_tr_b16 v[180:181], v10 offset:26624
ds_read_b64_tr_b16 v[182:183], v10 offset:27648
ds_read_b64_tr_b16 v[184:185], v10 offset:28672
ds_read_b64_tr_b16 v[186:187], v10 offset:29696
ds_read_b64_tr_b16 v[188:189], v10 offset:30720
ds_read_b64_tr_b16 v[190:191], v10 offset:31744
s_waitcnt lgkmcnt(4)
v_xor_b32 v15, 0, v12
ds_read_b64_tr_b16 v[192:193], v15 offset:0
ds_read_b64_tr_b16 v[194:195], v15 offset:16384
v_xor_b32 v15, 32, v12
ds_read_b64_tr_b16 v[196:197], v15 offset:0
ds_read_b64_tr_b16 v[198:199], v15 offset:16384
v_xor_b32 v15, 64, v12
ds_read_b64_tr_b16 v[200:201], v15 offset:0
ds_read_b64_tr_b16 v[202:203], v15 offset:16384
v_xor_b32 v15, 96, v12
ds_read_b64_tr_b16 v[204:205], v15 offset:0
ds_read_b64_tr_b16 v[206:207], v15 offset:16384
s_waitcnt lgkmcnt(4)
v_xor_b32 v15, 128, v12
ds_read_b64_tr_b16 v[208:209], v15 offset:0
ds_read_b64_tr_b16 v[210:211], v15 offset:16384
v_xor_b32 v15, 160, v12
ds_read_b64_tr_b16 v[212:213], v15 offset:0
ds_read_b64_tr_b16 v[214:215], v15 offset:16384
v_xor_b32 v15, 192, v12
ds_read_b64_tr_b16 v[216:217], v15 offset:0
ds_read_b64_tr_b16 v[218:219], v15 offset:16384
v_xor_b32 v15, 224, v12
ds_read_b64_tr_b16 v[220:221], v15 offset:0
ds_read_b64_tr_b16 v[222:223], v15 offset:16384
s_waitcnt lgkmcnt(4)
MN_105:
s_waitcnt vmcnt(0)
v_cmp_ne_u32 vcc, s68, v17
s_cbranch_vccz PD_104
s_add_u32 s34, s34, 1
s_cmp_lt_u32 s34, 2097152
s_cbranch_scc0 L_done
s_sleep 1
s_branch MB_103
PD_104:
P_106:
buffer_load_dwordx4 v[16:19], v9, s[36:39], s54 offen offset:0 sc1
buffer_load_dwordx4 v[20:23], v9, s[36:39], s54 offen offset:512 sc1
buffer_load_dwordx4 v[24:27], v9, s[36:39], s55 offen offset:0 sc1
buffer_load_dwordx4 v[28:31], v9, s[36:39], s55 offen offset:512 sc1
buffer_load_dwordx4 v[32:35], v9, s[36:39], s54 offen offset:256 sc1
buffer_load_dwordx4 v[36:39], v9, s[36:39], s54 offen offset:768 sc1
buffer_load_dwordx4 v[40:43], v9, s[36:39], s55 offen offset:256 sc1
buffer_load_dwordx4 v[44:47], v9, s[36:39], s55 offen offset:768 sc1
s_waitcnt vmcnt(7)
v_mfma_f32_16x16x32_bf16 v[64:67], v[48:51], v[16:19], v[224:227]
v_max3_u32 v15, v16, v17, v18
v_max_u32 v15, v15, v19
s_waitcnt vmcnt(6)
v_mfma_f32_16x16x32_bf16 v[68:71], v[48:51], v[20:23], v[228:231]
v_max3_u32 v15, v15, v20, v21
v_max3_u32 v15, v15, v22, v23
s_waitcnt vmcnt(5)
v_mfma_f32_16x16x32_bf16 v[64:67], v[48:51], v[24:27], v[64:67]
v_max3_u32 v15, v15, v24, v25
v_max3_u32 v15, v15, v26, v27
s_waitcnt vmcnt(4)
v_mfma_f32_16x16x32_bf16 v[68:71], v[48:51], v[28:31], v[68:71]
v_max3_u32 v15, v15, v28, v29
v_max3_u32 v15, v15, v30, v31
s_waitcnt vmcnt(3)
v_mfma_f32_16x16x32_bf16 v[64:67], v[52:55], v[32:35], v[64:67]
v_max3_u32 v15, v15, v32, v33
v_max3_u32 v15, v15, v34, v35
s_waitcnt vmcnt(2)
v_mfma_f32_16x16x32_bf16 v[68:71], v[52:55], v[36:39], v[68:71]
v_max3_u32 v15, v15, v36, v37
v_max3_u32 v15, v15, v38, v39
s_waitcnt vmcnt(1)
v_mfma_f32_16x16x32_bf16 v[64:67], v[52:55], v[40:43], v[64:67]
v_max3_u32 v15, v15, v40, v41
v_max3_u32 v15, v15, v42, v43
s_waitcnt vmcnt(0)
v_mfma_f32_16x16x32_bf16 v[68:71], v[52:55], v[44:47], v[68:71]
v_max3_u32 v15, v15, v44, v45
v_max3_u32 v15, v15, v46, v47
v_cmp_eq_u32 vcc, -1, v15
s_cbranch_vccz PD_107
s_add_u32 s34, s34, 1
s_cmp_lt_u32 s34, 2097152
s_cbranch_scc0 L_done
s_sleep 1
s_branch P_106
PD_107:
s_nop 3
v_pk_add_f32 v[72:73], v[64:65], v[66:67]
v_pk_mul_f32 v[74:75], v[64:65], v[64:65]
v_pk_add_f32 v[76:77], v[68:69], v[70:71]
v_pk_fma_f32 v[74:75], v[66:67], v[66:67], v[74:75]
v_pk_add_f32 v[72:73], v[72:73], v[76:77]
v_pk_fma_f32 v[74:75], v[68:69], v[68:69], v[74:75]
v_add_f32 v72, v72, v73
v_pk_fma_f32 v[74:75], v[70:71], v[70:71], v[74:75]
v_add_f32 v73, v74, v75
v_add_f32_dpp v72, v72, v72 quad_perm:[1,0,3,2] row_mask:0xf bank_mask:0xf
s_nop 0
v_add_f32_dpp v73, v73, v73 quad_perm:[1,0,3,2] row_mask:0xf bank_mask:0xf
v_add_f32_dpp v72, v72, v72 quad_perm:[2,3,0,1] row_mask:0xf bank_mask:0xf
s_nop 0
v_add_f32_dpp v73, v73, v73 quad_perm:[2,3,0,1] row_mask:0xf bank_mask:0xf
v_add_f32_dpp v72, v72, v72 row_ror:4 row_mask:0xf bank_mask:0xf
s_nop 0
v_add_f32_dpp v73, v73, v73 row_ror:4 row_mask:0xf bank_mask:0xf
v_add_f32_dpp v72, v72, v72 row_ror:8 row_mask:0xf bank_mask:0xf
s_nop 0
v_add_f32_dpp v73, v73, v73 row_ror:8 row_mask:0xf bank_mask:0xf
v_mov_b32 v74, v72
v_mov_b32 v75, v73
s_nop 0
v_permlane16_swap_b32 v72, v74
v_permlane16_swap_b32 v73, v75
v_add_f32 v72, v72, v74
v_add_f32 v73, v73, v75
v_mov_b32 v74, v72
v_mov_b32 v75, v73
s_nop 0
v_permlane32_swap_b32 v72, v74
v_permlane32_swap_b32 v73, v75
v_add_f32 v72, v72, v74
v_add_f32 v73, v73, v75
v_mul_f32 v72, 0x3b000000, v72
v_mul_f32 v73, 0x3b000000, v73
v_fma_f32 v73, -v72, v72, v73
v_max_f32 v73, 0, v73
v_add_f32 v73, 0x3727c5ac, v73
v_rsq_f32 v73, v73
s_nop 0
v_mul_f32_e64 v72, -v72, v73
v_fma_f32 v64, v64, v73, v72
v_fma_f32 v65, v65, v73, v72
v_fma_f32 v66, v66, v73, v72
v_fma_f32 v67, v67, v73, v72
v_fma_f32 v68, v68, v73, v72
v_fma_f32 v69, v69, v73, v72
v_fma_f32 v70, v70, v73, v72
v_fma_f32 v71, v71, v73, v72
v_cvt_pk_bf16_f32 v80, v64, v65
v_cvt_pk_bf16_f32 v81, v66, v67
v_cvt_pk_bf16_f32 v82, v68, v69
v_cvt_pk_bf16_f32 v83, v70, v71
ds_write_b64 v8, v[80:81]
ds_write_b64 v8, v[82:83] offset:512
s_waitcnt lgkmcnt(0)
s_barrier
s_cmp_lg_u32 s57, 0
s_cbranch_scc1 L_mrdy
ds_read_b64_tr_b16 v[128:129], v10 offset:0
ds_read_b64_tr_b16 v[130:131], v10 offset:1024
ds_read_b64_tr_b16 v[132:133], v10 offset:2048
ds_read_b64_tr_b16 v[134:135], v10 offset:3072
ds_read_b64_tr_b16 v[136:137], v10 offset:4096
ds_read_b64_tr_b16 v[138:139], v10 offset:5120
ds_read_b64_tr_b16 v[140:141], v10 offset:6144
ds_read_b64_tr_b16 v[142:143], v10 offset:7168
s_waitcnt lgkmcnt(4)
ds_read_b64_tr_b16 v[144:145], v10 offset:8192
ds_read_b64_tr_b16 v[146:147], v10 offset:9216
ds_read_b64_tr_b16 v[148:149], v10 offset:10240
ds_read_b64_tr_b16 v[150:151], v10 offset:11264
ds_read_b64_tr_b16 v[152:153], v10 offset:12288
ds_read_b64_tr_b16 v[154:155], v10 offset:13312
ds_read_b64_tr_b16 v[156:157], v10 offset:14336
ds_read_b64_tr_b16 v[158:159], v10 offset:15360
s_waitcnt lgkmcnt(4)
ds_read_b64_tr_b16 v[160:161], v10 offset:16384
ds_read_b64_tr_b16 v[162:163], v10 offset:17408
ds_read_b64_tr_b16 v[164:165], v10 offset:18432
ds_read_b64_tr_b16 v[166:167], v10 offset:19456
ds_read_b64_tr_b16 v[168:169], v10 offset:20480
ds_read_b64_tr_b16 v[170:171], v10 offset:21504
ds_read_b64_tr_b16 v[172:173], v10 offset:22528
ds_read_b64_tr_b16 v[174:175], v10 offset:23552
s_waitcnt lgkmcnt(4)
ds_read_b64_tr_b16 v[176:177], v10 offset:24576
ds_read_b64_tr_b16 v[178:179], v10 offset:25600
ds_read_b64_tr_b16 v[180:181], v10 offset:26624
ds_read_b64_tr_b16 v[182:183], v10 offset:27648
ds_read_b64_tr_b16 v[184:185], v10 offset:28672
ds_read_b64_tr_b16 v[186:187], v10 offset:29696
ds_read_b64_tr_b16 v[188:189], v10 offset:30720
ds_read_b64_tr_b16 v[190:191], v10 offset:31744
s_waitcnt lgkmcnt(4)
v_xor_b32 v15, 0, v12
ds_read_b64_tr_b16 v[192:193], v15 offset:0
ds_read_b64_tr_b16 v[194:195], v15 offset:16384
v_xor_b32 v15, 32, v12
ds_read_b64_tr_b16 v[196:197], v15 offset:0
ds_read_b64_tr_b16 v[198:199], v15 offset:16384
v_xor_b32 v15, 64, v12
ds_read_b64_tr_b16 v[200:201], v15 offset:0
ds_read_b64_tr_b16 v[202:203], v15 offset:16384
v_xor_b32 v15, 96, v12
ds_read_b64_tr_b16 v[204:205], v15 offset:0
ds_read_b64_tr_b16 v[206:207], v15 offset:16384
s_waitcnt lgkmcnt(4)
v_xor_b32 v15, 128, v12
ds_read_b64_tr_b16 v[208:209], v15 offset:0
ds_read_b64_tr_b16 v[210:211], v15 offset:16384
v_xor_b32 v15, 160, v12
ds_read_b64_tr_b16 v[212:213], v15 offset:0
ds_read_b64_tr_b16 v[214:215], v15 offset:16384
v_xor_b32 v15, 192, v12
ds_read_b64_tr_b16 v[216:217], v15 offset:0
ds_read_b64_tr_b16 v[218:219], v15 offset:16384
v_xor_b32 v15, 224, v12
ds_read_b64_tr_b16 v[220:221], v15 offset:0
ds_read_b64_tr_b16 v[222:223], v15 offset:16384
s_waitcnt lgkmcnt(4)
s_waitcnt lgkmcnt(0)
L_mrdy:
ds_read_b128 v[64:67], v13 offset:0
ds_read_b128 v[68:71], v13 offset:64
ds_read_b128 v[72:75], v13 offset:128
ds_read_b128 v[76:79], v13 offset:192
ds_read_b128 v[80:83], v13 offset:256
ds_read_b128 v[84:87], v13 offset:320
ds_read_b128 v[88:91], v13 offset:384
ds_read_b128 v[92:95], v13 offset:448
ds_read_b128 v[96:99], v13 offset:512
ds_read_b128 v[100:103], v13 offset:576
ds_read_b128 v[104:107], v13 offset:640
ds_read_b128 v[108:111], v13 offset:704
ds_read_b128 v[112:115], v13 offset:768
ds_read_b128 v[116:119], v13 offset:832
ds_read_b128 v[120:123], v13 offset:896
s_waitcnt lgkmcnt(14)
ds_read_b128 v[124:127], v13 offset:960
v_mfma_f32_16x16x32_bf16 v[16:19], v[128:131], v[64:67], 0
s_waitcnt lgkmcnt(14)
v_mfma_f32_16x16x32_bf16 v[20:23], v[132:135], v[68:71], 0
s_waitcnt lgkmcnt(13)
v_mfma_f32_16x16x32_bf16 v[16:19], v[136:139], v[72:75], v[16:19]
s_waitcnt lgkmcnt(12)
v_mfma_f32_16x16x32_bf16 v[20:23], v[140:143], v[76:79], v[20:23]
s_waitcnt lgkmcnt(11)
v_mfma_f32_16x16x32_bf16 v[16:19], v[144:147], v[80:83], v[16:19]
s_waitcnt lgkmcnt(10)
v_mfma_f32_16x16x32_bf16 v[20:23], v[148:151], v[84:87], v[20:23]
s_waitcnt lgkmcnt(9)
v_mfma_f32_16x16x32_bf16 v[16:19], v[152:155], v[88:91], v[16:19]
s_waitcnt lgkmcnt(8)
v_mfma_f32_16x16x32_bf16 v[20:23], v[156:159], v[92:95], v[20:23]
s_waitcnt lgkmcnt(7)
v_mfma_f32_16x16x32_bf16 v[16:19], v[160:163], v[96:99], v[16:19]
s_waitcnt lgkmcnt(6)
v_mfma_f32_16x16x32_bf16 v[20:23], v[164:167], v[100:103], v[20:23]
s_waitcnt lgkmcnt(5)
v_mfma_f32_16x16x32_bf16 v[16:19], v[168:171], v[104:107], v[16:19]
s_waitcnt lgkmcnt(4)
v_mfma_f32_16x16x32_bf16 v[20:23], v[172:175], v[108:111], v[20:23]
s_waitcnt lgkmcnt(3)
v_mfma_f32_16x16x32_bf16 v[16:19], v[176:179], v[112:115], v[16:19]
s_waitcnt lgkmcnt(2)
v_mfma_f32_16x16x32_bf16 v[20:23], v[180:183], v[116:119], v[20:23]
s_waitcnt lgkmcnt(1)
v_mfma_f32_16x16x32_bf16 v[16:19], v[184:187], v[120:123], v[16:19]
s_waitcnt lgkmcnt(0)
v_mfma_f32_16x16x32_bf16 v[20:23], v[188:191], v[124:127], v[20:23]
s_nop 7
v_pk_add_f32 v[16:17], v[16:17], v[20:21]
v_pk_add_f32 v[18:19], v[18:19], v[22:23]
s_mov_b64 exec, s[60:61]
v_max_f32 v16, s58, v16
v_max_f32 v17, s58, v17
v_max_f32 v18, s58, v18
v_max_f32 v19, s58, v19
ds_write_b128 v56, v[16:19] offset:4096
s_mov_b64 exec, -1
s_waitcnt lgkmcnt(0)
s_barrier
ds_read_b128 v[32:35], v57 offset:4096
ds_read_b128 v[40:43], v57 offset:4608
ds_read_b128 v[36:39], v57 offset:4112
ds_read_b128 v[44:47], v57 offset:4624
s_waitcnt lgkmcnt(0)
v_pk_mul_f32 v[32:33], v[32:33], v[40:41]
v_pk_mul_f32 v[34:35], v[34:35], v[42:43]
v_pk_mul_f32 v[36:37], v[36:37], v[44:45]
v_pk_mul_f32 v[38:39], v[38:39], v[46:47]
v_cvt_pk_bf16_f32 v48, v32, v33
v_cvt_pk_bf16_f32 v49, v34, v35
v_cvt_pk_bf16_f32 v50, v36, v37
v_cvt_pk_bf16_f32 v51, v38, v39
s_nop 1
v_mfma_f32_16x16x32_bf16 v[64:67], v[192:195], v[48:51], 0
v_mfma_f32_16x16x32_bf16 v[80:83], v[208:211], v[48:51], 0
v_mfma_f32_16x16x32_bf16 v[68:71], v[196:199], v[48:51], 0
v_mfma_f32_16x16x32_bf16 v[84:87], v[212:215], v[48:51], 0
v_mfma_f32_16x16x32_bf16 v[72:75], v[200:203], v[48:51], 0
v_mfma_f32_16x16x32_bf16 v[88:91], v[216:219], v[48:51], 0
v_mfma_f32_16x16x32_bf16 v[76:79], v[204:207], v[48:51], 0
v_mfma_f32_16x16x32_bf16 v[92:95], v[220:223], v[48:51], 0
s_mov_b64 exec, s[60:61]
v_cvt_pk_bf16_f32 v16, v64, v65
v_cvt_pk_bf16_f32 v17, v66, v67
v_cvt_pk_bf16_f32 v18, v80, v81
v_cvt_pk_bf16_f32 v19, v82, v83
s_mov_b64 exec, s[62:63]
v_cvt_pk_bf16_f32 v16, v68, v69
v_cvt_pk_bf16_f32 v17, v70, v71
v_cvt_pk_bf16_f32 v18, v84, v85
v_cvt_pk_bf16_f32 v19, v86, v87
s_mov_b64 exec, s[64:65]
v_cvt_pk_bf16_f32 v16, v72, v73
v_cvt_pk_bf16_f32 v17, v74, v75
v_cvt_pk_bf16_f32 v18, v88, v89
v_cvt_pk_bf16_f32 v19, v90, v91
s_mov_b64 exec, s[66:67]
v_cvt_pk_bf16_f32 v16, v76, v77
v_cvt_pk_bf16_f32 v17, v78, v79
v_cvt_pk_bf16_f32 v18, v92, v93
v_cvt_pk_bf16_f32 v19, v94, v95
s_mov_b64 exec, -1
v_min_u32 v16, -2, v16
v_min_u32 v17, -2, v17
v_min_u32 v18, -2, v18
v_min_u32 v19, -2, v19
buffer_store_dwordx4 v[16:19], v7, s[36:39], s56 offen sc1
s_cmp_lg_u32 s5, 0
s_cbranch_scc1 L_nor2
v_mov_b32 v20, 0
v_mov_b32 v21, s68
s_mov_b64 exec, 1
s_cmp_eq_u32 s35, 1
s_cbranch_scc1 SL_108
buffer_store_dword v21, v20, s[36:39], s59 offen sc1
s_branch SE_109
SL_108:
buffer_store_dword v21, v20, s[36:39], s59 offen
SE_109:
buffer_store_dword v21, v20, s[36:39], s59 offen offset:1024 sc1
s_mov_b64 exec, -1
L_nor2:
s_endpgm
L_final:
s_mov_b32 s44, s28
s_and_b32 s45, s29, 0xffff
s_mov_b32 s46, 4096
s_mov_b32 s47, 0x20000
s_lshl_b32 s54, s3, 2
s_add_u32 s54, s54, s4
v_lshlrev_b32 v9, 5, v3
v_and_b32 v13, 1, v4
v_lshl_add_u32 v9, v13, 7, v9
v_lshl_add_u32 v8, v2, 10, v9
s_lshr_b32 s55, s54, 2
s_lshl_b32 s55, s55, 8
s_and_b32 s6, s54, 3
s_lshl_b32 s6, s6, 3
s_add_u32 s55, s55, s6
v_mul_u32_u24 v13, 1040, v2
v_add_u32 v9, v9, v13
s_add_u32 s6, s55, 147456
v_add_u32 v9, s6, v9
ds_read_b64 v[10:11], v9
v_lshlrev_b32 v12, 12, v4
v_lshl_add_u32 v12, v5, 4, v12
s_lshl_b32 s56, s54, 8
s_add_u32 s56, s56, 786432
v_and_b32 v14, 1, v5
v_lshlrev_b32 v14, 4, v14
v_mov_b32 v15, 0x3f80
v_lshlrev_b32 v14, v14, v15
v_lshrrev_b32 v15, 1, v5
v_cmp_eq_u32 vcc, 0, v15
s_nop 1
v_cndmask_b32 v48, 0, v14, vcc
v_cmp_eq_u32 vcc, 1, v15
s_nop 1
v_cndmask_b32 v49, 0, v14, vcc
v_cmp_eq_u32 vcc, 2, v15
s_nop 1
v_cndmask_b32 v50, 0, v14, vcc
v_cmp_eq_u32 vcc, 3, v15
s_nop 1
v_cndmask_b32 v51, 0, v14, vcc
W_110:
ds_read_b32 v14, v1 offset:352
s_waitcnt lgkmcnt(0)
v_cmp_le_u32 vcc, 1, v14
s_cbranch_vccnz D_111
s_add_u32 s34, s34, 1
s_cmp_lt_u32 s34, 2097152
s_cbranch_scc0 L_done
s_sleep 4
s_branch W_110
D_111:
v_readfirstlane_b32 s35, v14
s_nop 0
s_sub_u32 s35, s35, 1
s_lshl_b32 s7, s3, 11
s_add_u32 s7, s7, 704512
s_cmp_eq_u32 s35, 1
s_cselect_b32 s6, 7, 7
v_and_b32 v16, 7, v0
v_lshlrev_b32 v16, s6, v16
s_cselect_b32 s6, 0, 1024
s_add_u32 s7, s7, s6
DB_112:
buffer_load_dword v17, v16, s[36:39], s7 offen sc1
s_waitcnt vmcnt(0)
v_cmp_ne_u32 vcc, s68, v17
s_cbranch_vccz PD_113
s_add_u32 s34, s34, 1
s_cmp_lt_u32 s34, 2097152
s_cbranch_scc0 L_done
s_sleep 4
s_branch DB_112
PD_113:
P_114:
s_add_u32 s57, s55, 1835008
buffer_load_dwordx2 v[16:17], v8, s[36:39], s57 offen sc1
s_add_u32 s57, s57, 4096
buffer_load_dwordx2 v[18:19], v8, s[36:39], s57 offen sc1
s_add_u32 s57, s57, 4096
buffer_load_dwordx2 v[20:21], v8, s[36:39], s57 offen sc1
s_add_u32 s57, s57, 4096
buffer_load_dwordx2 v[22:23], v8, s[36:39], s57 offen sc1
s_add_u32 s57, s57, 4096
buffer_load_dwordx2 v[24:25], v8, s[36:39], s57 offen sc1
s_add_u32 s57, s57, 4096
buffer_load_dwordx2 v[26:27], v8, s[36:39], s57 offen sc1
s_add_u32 s57, s57, 4096
buffer_load_dwordx2 v[28:29], v8, s[36:39], s57 offen sc1
s_add_u32 s57, s57, 4096
buffer_load_dwordx2 v[30:31], v8, s[36:39], s57 offen sc1
s_waitcnt vmcnt(0)
v_max3_u32 v15, v16, v17, v18
v_max3_u32 v15, v15, v19, v20
v_max3_u32 v15, v15, v21, v22
v_max3_u32 v15, v15, v23, v24
v_max3_u32 v15, v15, v25, v26
v_max3_u32 v15, v15, v27, v28
v_max3_u32 v15, v15, v29, v30
v_max_u32 v15, v15, v31
v_cmp_eq_u32 vcc, -1, v15
s_cbranch_vccz PD_115
s_add_u32 s34, s34, 1
s_cmp_lt_u32 s34, 2097152
s_cbranch_scc0 L_done
s_sleep 8
s_branch P_114
PD_115:
s_cmp_lg_u32 s54, 0
s_cbranch_scc1 L_noep
v_mov_b32 v36, s69
v_mov_b32 v37, 0
s_mov_b64 exec, 1
buffer_store_dword v36, v37, s[36:39], 0 offen sc1
s_mov_b64 exec, -1
L_noep:
s_waitcnt lgkmcnt(0)
v_lshlrev_b32 v52, 16, v10
v_and_b32 v53, 0xffff0000, v10
v_lshlrev_b32 v36, 16, v16
v_and_b32 v37, 0xffff0000, v16
v_pk_add_f32 v[52:53], v[52:53], v[36:37]
v_lshlrev_b32 v36, 16, v18
v_and_b32 v37, 0xffff0000, v18
v_pk_add_f32 v[52:53], v[52:53], v[36:37]
v_lshlrev_b32 v36, 16, v20
v_and_b32 v37, 0xffff0000, v20
v_pk_add_f32 v[52:53], v[52:53], v[36:37]
v_lshlrev_b32 v36, 16, v22
v_and_b32 v37, 0xffff0000, v22
v_pk_add_f32 v[52:53], v[52:53], v[36:37]
v_lshlrev_b32 v36, 16, v24
v_and_b32 v37, 0xffff0000, v24
v_pk_add_f32 v[52:53], v[52:53], v[36:37]
v_lshlrev_b32 v36, 16, v26
v_and_b32 v37, 0xffff0000, v26
v_pk_add_f32 v[52:53], v[52:53], v[36:37]
v_lshlrev_b32 v36, 16, v28
v_and_b32 v37, 0xffff0000, v28
v_pk_add_f32 v[52:53], v[52:53], v[36:37]
v_lshlrev_b32 v36, 16, v30
v_and_b32 v37, 0xffff0000, v30
v_pk_add_f32 v[52:53], v[52:53], v[36:37]
v_lshlrev_b32 v54, 16, v11
v_and_b32 v55, 0xffff0000, v11
v_lshlrev_b32 v36, 16, v17
v_and_b32 v37, 0xffff0000, v17
v_pk_add_f32 v[54:55], v[54:55], v[36:37]
v_lshlrev_b32 v36, 16, v19
v_and_b32 v37, 0xffff0000, v19
v_pk_add_f32 v[54:55], v[54:55], v[36:37]
v_lshlrev_b32 v36, 16, v21
v_and_b32 v37, 0xffff0000, v21
v_pk_add_f32 v[54:55], v[54:55], v[36:37]
v_lshlrev_b32 v36, 16, v23
v_and_b32 v37, 0xffff0000, v23
v_pk_add_f32 v[54:55], v[54:55], v[36:37]
v_lshlrev_b32 v36, 16, v25
v_and_b32 v37, 0xffff0000, v25
v_pk_add_f32 v[54:55], v[54:55], v[36:37]
v_lshlrev_b32 v36, 16, v27
v_and_b32 v37, 0xffff0000, v27
v_pk_add_f32 v[54:55], v[54:55], v[36:37]
v_lshlrev_b32 v36, 16, v29
v_and_b32 v37, 0xffff0000, v29
v_pk_add_f32 v[54:55], v[54:55], v[36:37]
v_lshlrev_b32 v36, 16, v31
v_and_b32 v37, 0xffff0000, v31
v_pk_add_f32 v[54:55], v[54:55], v[36:37]
s_lshl_b32 s7, s3, 11
s_add_u32 s7, s7, 1228800
s_cmp_eq_u32 s35, 1
s_cselect_b32 s6, 7, 7
v_and_b32 v16, 7, v0
v_lshlrev_b32 v16, s6, v16
s_cselect_b32 s6, 0, 1024
s_add_u32 s7, s7, s6
DB_116:
buffer_load_dword v17, v16, s[36:39], s7 offen sc1
s_waitcnt vmcnt(0)
v_cmp_ne_u32 vcc, s68, v17
s_cbranch_vccz PD_117
s_add_u32 s34, s34, 1
s_cmp_lt_u32 s34, 2097152
s_cbranch_scc0 L_done
s_sleep 1
s_branch DB_116
PD_117:
P_118:
s_mov_b32 s57, s56
buffer_load_dwordx4 v[64:67], v12, s[36:39], s57 offen sc1
s_add_u32 s57, s57, 16384
buffer_load_dwordx4 v[68:71], v12, s[36:39], s57 offen sc1
s_add_u32 s57, s57, 16384
buffer_load_dwordx4 v[72:75], v12, s[36:39], s57 offen sc1
s_add_u32 s57, s57, 16384
buffer_load_dwordx4 v[76:79], v12, s[36:39], s57 offen sc1
s_add_u32 s57, s57, 16384
buffer_load_dwordx4 v[80:83], v12, s[36:39], s57 offen sc1
s_add_u32 s57, s57, 16384
buffer_load_dwordx4 v[84:87], v12, s[36:39], s57 offen sc1
s_add_u32 s57, s57, 16384
buffer_load_dwordx4 v[88:91], v12, s[36:39], s57 offen sc1
s_add_u32 s57, s57, 16384
buffer_load_dwordx4 v[92:95], v12, s[36:39], s57 offen sc1
s_add_u32 s57, s57, 409600
buffer_load_dwordx4 v[96:99], v12, s[36:39], s57 offen sc1
s_add_u32 s57, s57, 16384
buffer_load_dwordx4 v[100:103], v12, s[36:39], s57 offen sc1
s_add_u32 s57, s57, 16384
buffer_load_dwordx4 v[104:107], v12, s[36:39], s57 offen sc1
s_add_u32 s57, s57, 16384
buffer_load_dwordx4 v[108:111], v12, s[36:39], s57 offen sc1
s_add_u32 s57, s57, 16384
buffer_load_dwordx4 v[112:115], v12, s[36:39], s57 offen sc1
s_add_u32 s57, s57, 16384
buffer_load_dwordx4 v[116:119], v12, s[36:39], s57 offen sc1
s_waitcnt vmcnt(13)
v_mfma_f32_16x16x32_bf16 v[40:43], v[48:51], v[64:67], v[52:55]
v_max3_u32 v15, v64, v65, v66
v_max_u32 v15, v15, v67
s_waitcnt vmcnt(12)
v_mfma_f32_16x16x32_bf16 v[44:47], v[48:51], v[68:71], 0
v_max3_u32 v15, v15, v68, v69
v_max3_u32 v15, v15, v70, v71
s_waitcnt vmcnt(11)
v_mfma_f32_16x16x32_bf16 v[40:43], v[48:51], v[72:75], v[40:43]
v_max3_u32 v15, v15, v72, v73
v_max3_u32 v15, v15, v74, v75
s_waitcnt vmcnt(10)
v_mfma_f32_16x16x32_bf16 v[44:47], v[48:51], v[76:79], v[44:47]
v_max3_u32 v15, v15, v76, v77
v_max3_u32 v15, v15, v78, v79
s_waitcnt vmcnt(9)
v_mfma_f32_16x16x32_bf16 v[40:43], v[48:51], v[80:83], v[40:43]
v_max3_u32 v15, v15, v80, v81
v_max3_u32 v15, v15, v82, v83
s_waitcnt vmcnt(8)
v_mfma_f32_16x16x32_bf16 v[44:47], v[48:51], v[84:87], v[44:47]
v_max3_u32 v15, v15, v84, v85
v_max3_u32 v15, v15, v86, v87
s_waitcnt vmcnt(7)
v_mfma_f32_16x16x32_bf16 v[40:43], v[48:51], v[88:91], v[40:43]
v_max3_u32 v15, v15, v88, v89
v_max3_u32 v15, v15, v90, v91
s_waitcnt vmcnt(6)
v_mfma_f32_16x16x32_bf16 v[44:47], v[48:51], v[92:95], v[44:47]
v_max3_u32 v15, v15, v92, v93
v_max3_u32 v15, v15, v94, v95
s_waitcnt vmcnt(5)
v_mfma_f32_16x16x32_bf16 v[40:43], v[48:51], v[96:99], v[40:43]
v_max3_u32 v15, v15, v96, v97
v_max3_u32 v15, v15, v98, v99
s_waitcnt vmcnt(4)
v_mfma_f32_16x16x32_bf16 v[44:47], v[48:51], v[100:103], v[44:47]
v_max3_u32 v15, v15, v100, v101
v_max3_u32 v15, v15, v102, v103
s_waitcnt vmcnt(3)
v_mfma_f32_16x16x32_bf16 v[40:43], v[48:51], v[104:107], v[40:43]
v_max3_u32 v15, v15, v104, v105
v_max3_u32 v15, v15, v106, v107
s_waitcnt vmcnt(2)
v_mfma_f32_16x16x32_bf16 v[44:47], v[48:51], v[108:111], v[44:47]
v_max3_u32 v15, v15, v108, v109
v_max3_u32 v15, v15, v110, v111
s_waitcnt vmcnt(1)
v_mfma_f32_16x16x32_bf16 v[40:43], v[48:51], v[112:115], v[40:43]
v_max3_u32 v15, v15, v112, v113
v_max3_u32 v15, v15, v114, v115
s_waitcnt vmcnt(0)
v_mfma_f32_16x16x32_bf16 v[44:47], v[48:51], v[116:119], v[44:47]
v_max3_u32 v15, v15, v116, v117
v_max3_u32 v15, v15, v118, v119
v_cmp_eq_u32 vcc, -1, v15
s_cbranch_vccz PD_119
s_add_u32 s34, s34, 1
s_cmp_lt_u32 s34, 2097152
s_cbranch_scc0 L_done
s_sleep 1
s_branch P_118
PD_119:
s_nop 3
v_pk_add_f32 v[40:41], v[40:41], v[44:45]
v_pk_add_f32 v[42:43], v[42:43], v[46:47]
v_cvt_pk_bf16_f32 v44, v40, v41
v_cvt_pk_bf16_f32 v45, v42, v43
s_mov_b32 exec_hi, 0
buffer_store_dwordx2 v[44:45], v8, s[44:47], s55 offen
s_mov_b64 exec, -1
s_endpgm
L_done:
s_endpgm
L_codeend:
.fill 2665, 4, 0xbf810000
.section .rodata,"a"
.p2align 6
.amdhsa_kernel sequential_preLN__compressed_kv_cla__glu_gated_reglu__decode_kernel
  .amdhsa_next_free_vgpr 256
  .amdhsa_next_free_sgpr 102
  .amdhsa_accum_offset 256
  .amdhsa_group_segment_fixed_size 0
  .amdhsa_kernarg_size 104
  .amdhsa_user_sgpr_count 2
  .amdhsa_user_sgpr_kernarg_segment_ptr 1
  .amdhsa_system_sgpr_workgroup_id_x 1
.end_amdhsa_kernel
.text
```
